```python
import torch

def _softmax(x, axis=-1):
    return torch.softmax(x, dim=axis)
def _gelu(x):
    return torch.nn.functional.gelu(x, approximate="tanh")
def _silu(x):
    return torch.nn.functional.silu(x)
def _sigmoid(x):
    return torch.sigmoid(x)
def _layernorm(x, axis=-1, eps=1e-5):
    m = x.mean(dim=axis, keepdim=True)
    v = x.var(dim=axis, keepdim=True, unbiased=False)
    return (x - m) / torch.sqrt(v + eps)
def _scatter_add(tgt, idx, src, axis=0):
    return tgt.clone().index_add_(axis, idx, src)
def _segment_sum(src, seg, n):
    out = torch.zeros((n,) + src.shape[1:], dtype=src.dtype)
    return out.index_add_(0, seg, src)
def _pad(x, pw):
    flat = tuple(v for pair in reversed(pw) for v in pair)
    return torch.nn.functional.pad(x, flat)

kernel_name = 'standalone__edge_featured_mpnn_egc__graph'

def setup_inputs():

    _w = (lambda a: (lambda t: t.to(torch.bfloat16) if t.is_floating_point() else t)(torch.as_tensor(a)))
    N, deg, D, De = 10000, 64, 64, max(16, 1)
    E = N * deg
    return {
        "x": _w((lambda *s: torch.randn(*s, dtype=torch.bfloat16) * 0.2)(N, D)),
        "e_attr": _w((lambda *s: torch.randn(*s, dtype=torch.bfloat16) * 0.2)(E, De)),
        "src": _w((lambda lo, hi, *s: torch.randint(lo, hi, s))(0, N, E).to(torch.int64)),
        "dst": _w((lambda lo, hi, *s: torch.randint(lo, hi, s))(0, N, E).to(torch.int64)),
        "u_w": _w((lambda *s: torch.randn(*s, dtype=torch.bfloat16) * 0.05)(D, D)),
        "v_w": _w((lambda *s: torch.randn(*s, dtype=torch.bfloat16) * 0.05)(D, D)),
        "g_w": _w((lambda *s: torch.randn(*s, dtype=torch.bfloat16) * 0.2)(2 * D + De, D)),
    }

def reference(x, e_attr, src, dst, u_w, v_w, g_w):
    N, D = x.shape
    g_in = torch.concatenate([x[dst], x[src], e_attr], axis=-1)
    eta = _sigmoid(g_in @ g_w)
    hv = x @ v_w
    msg = eta * hv[src]
    agg = _segment_sum(msg, dst, N)
    return _silu(x @ u_w + agg)
```

```asm
; @launch grid=(256,1,1) block=(512,1,1) lds=160384
.amdgcn_target "amdgcn-amd-amdhsa--gfx950"
.text
.globl standalone__edge_featured_mpnn_egc__graph_kernel
.p2align 8
.type standalone__edge_featured_mpnn_egc__graph_kernel,@function
standalone__edge_featured_mpnn_egc__graph_kernel:
    s_cmp_ge_u32 s2, 256
    s_cbranch_scc1 B_end
    s_load_dwordx16 s[4:19], s[0:1], 0
    s_load_dwordx2 s[22:23], s[0:1], 72
    v_lshrrev_b32 v1, 6, v0
    s_getpc_b64 s[46:47]
B_pc:
    v_mul_u32_u24 v55, 50, v1
    v_sub_u32 v55, v0, v55
    v_lshlrev_b32 v55, 7, v55
    v_min_u32 v55, B_warm_end-B_pc, v55
    s_mov_b64 exec, 0x3fff
    global_load_dword v55, v55, s[46:47]
    s_mov_b64 exec, -1
    s_mul_i32 s3, s2, 10000
    v_readfirstlane_b32 s40, v1
    v_lshlrev_b32 v23, 4, v0
    v_add_u32 v24, s3, v23
    s_add_u32 s3, s3, 8192
    v_lshl_add_u32 v25, v0, 2, s3
    s_movk_i32 s3, 452
    v_cmp_gt_u32 s[44:45], s3, v0
    v_and_b32 v7, 63, v0
    v_mov_b32 v16, 0
    v_lshlrev_b32 v10, 2, v0
    v_lshlrev_b32 v5, 2, v7
    ds_write_b32 v10, v16 offset:30976
    ds_write_b32 v5, v16 offset:30720
    s_and_b32 s100, s2, 7
    s_lshl_b32 s100, s100, 5
    s_lshr_b32 s3, s2, 3
    s_add_u32 s100, s100, s3
    s_mul_i32 s80, s100, 625
    s_add_u32 s81, s80, 640
    s_add_u32 s80, s80, 15
    s_lshr_b32 s80, s80, 4
    v_and_b32 v13, 7, v7
    v_and_b32 v12, 16, v0
    v_lshlrev_b32 v12, 2, v12
    v_xor_b32 v28, v23, v12
    v_and_b32 v43, 0x7f, v28
    s_lshl_b32 s3, s40, 8
    s_add_u32 s3, s3, 16384
    v_lshl_add_u32 v29, v7, 4, s3
    v_add_u32 v54, 8192, v23
    s_mov_b32 s26, 10000
    s_mov_b32 s27, 0x20000
    s_mov_b32 s38, 4718848
    s_mov_b32 s39, 0x20000
    s_waitcnt lgkmcnt(0)
    global_load_dwordx4 v[120:123], v24, s[10:11]
    s_mov_b64 exec, s[44:45]
    global_load_dword v124, v25, s[10:11]
    s_mov_b64 exec, -1
    s_load_dword s97, s[22:23], 0
    s_barrier
    global_load_dwordx4 v[128:131], v24, s[8:9]
    s_mov_b64 exec, s[44:45]
    global_load_dword v132, v25, s[8:9]
    s_mov_b64 exec, -1
    global_load_dwordx4 v[160:163], v54, s[16:17]
    s_mov_b64 exec, 0xffff
    global_load_dwordx4 v[164:167], v29, s[16:17]
    s_mov_b64 exec, -1
    s_mov_b32 s24, s4
    s_and_b32 s25, s5, 0xffff
    s_or_b32 s25, s25, 8388608
    s_mov_b32 s36, s22
    s_and_b32 s37, s23, 0xffff
    s_and_b32 s42, s40, 1
    s_lshl_b32 s42, s42, 6
    v_xor_b32 v30, s42, v29
    s_and_b32 s42, s40, 3
    s_lshr_b32 s3, s40, 2
    s_lshl_b32 s3, s3, 4
    s_add_u32 s3, s3, s42
    s_lshl_b32 s3, s3, 1
    v_lshrrev_b32 v12, 4, v7
    v_lshl_add_u32 v32, v12, 3, s3
    v_bfe_u32 v12, v7, 3, 1
    v_add_u32 v32, v32, v12
    v_cmp_gt_u32 vcc, 40, v32
    v_add_u32 v32, s80, v32
    s_lshl_b32 s42, s42, 4
    v_xor_b32 v33, s42, v43
    v_cndmask_b32 v32, -1, v32, vcc
    v_lshrrev_b32 v12, 3, v7
    s_and_b32 s3, s2, -8
    s_add_u32 s3, s3, s40
    s_mul_i32 s3, s3, 40
    v_add_u32 v52, s3, v7
    s_lshl_b32 s43, s40, 10
    v_lshl_add_u32 v15, v12, 3, s40
    v_add_u32 v15, 64, v15
    v_lshlrev_b32 v31, 4, v13
    v_lshl_add_u32 v31, v15, 7, v31
    s_lshl_b32 s3, s40, 7
    v_lshl_add_u32 v14, v7, 3, s3
    s_mul_i32 s41, s40, 5120
    s_add_u32 s41, s41, 30976
    v_bfe_u32 v10, v7, 2, 1
    v_and_b32 v13, 3, v7
    v_lshl_add_u32 v10, v10, 4, v13
    v_bfe_u32 v11, v7, 3, 2
    v_lshl_add_u32 v10, v11, 2, v10
    v_lshrrev_b32 v11, 5, v7
    v_bfe_u32 v12, v10, 1, 3
    v_xor_b32 v12, v12, v11
    v_bfe_u32 v1, v10, 1, 2
    v_lshl_add_u32 v1, v1, 10, s41
    v_lshrrev_b32 v8, 3, v10
    v_lshl_add_u32 v1, v8, 8, v1
    v_and_b32 v8, 1, v10
    v_lshl_add_u32 v1, v8, 7, v1
    v_xor_b32 v38, 0, v12
    v_lshl_add_u32 v38, v38, 4, v1
    v_xor_b32 v39, 2, v12
    v_lshl_add_u32 v39, v39, 4, v1
    v_xor_b32 v40, 4, v12
    v_lshl_add_u32 v40, v40, 4, v1
    v_xor_b32 v41, 6, v12
    v_lshl_add_u32 v41, v41, 4, v1
    v_bfe_u32 v12, v10, 3, 1
    v_xor_b32 v12, v12, v11
    v_lshlrev_b32 v12, 4, v12
    v_lshl_add_u32 v12, v10, 5, v12
    s_add_u32 s42, s41, 4096
    v_add_u32 v37, s42, v12
    v_bfe_u32 v12, v7, 2, 2
    v_lshl_add_u32 v12, v11, 3, v12
    v_lshlrev_b32 v12, 7, v12
    v_lshl_add_u32 v12, v13, 3, v12
    v_bfe_u32 v13, v7, 4, 1
    v_lshl_add_u32 v12, v13, 5, v12
    v_bfe_u32 v13, v7, 3, 1
    v_lshl_add_u32 v12, v13, 6, v12
    v_add_u32 v70, 71936, v12
    v_xor_b32 v71, 64, v70
    s_bfe_u32 s8, s40, 0x10001
    s_lshl_b32 s3, s8, 12
    s_sub_u32 s3, s3, s41
    s_add_u32 s3, s3, 55552
    v_add_u32 v56, s3, v38
    v_add_u32 v57, s3, v39
    v_add_u32 v58, s3, v40
    v_add_u32 v59, s3, v41
    s_lshr_b32 s20, s40, 2
    s_and_b32 s21, s40, 1
    s_mul_i32 s3, s20, 26624
    s_lshl_b32 s42, s21, 6
    v_xor_b32 v67, s42, v70
    v_add_u32 v67, s3, v67
    v_lshrrev_b32 v11, 5, v7
    v_mul_u32_u24 v54, 12288, v11
    v_mov_b32 v16, 2147483647
    v_mov_b32 v17, 2147483647
    v_mov_b32 v18, 2147483647
    v_mov_b32 v19, 2147483647
    v_mov_b32 v10, 119360
    v_lshl_add_u32 v10, v0, 4, v10
    ds_write_b128 v10, v[16:19] offset:0
    ds_write_b128 v10, v[16:19] offset:8192
    ds_write_b128 v10, v[16:19] offset:16384
    ds_write_b128 v10, v[16:19] offset:24576
    ds_write_b128 v10, v[16:19] offset:32768
    s_mov_b64 exec, 15
    ds_write_b128 v10, v[16:19] offset:40960
    s_mov_b64 exec, -1
    v_cmp_gt_u32 vcc, 400, v0
    v_mov_b32 v16, 119360
    v_mov_b32 v17, 0
    v_mov_b32 v11, 112896
    v_cndmask_b32 v16, 0, v16, vcc
    v_cmp_ge_u32 vcc, 400, v0
    v_lshl_add_u32 v11, v0, 4, v11
    v_mov_b64 v[18:19], v[16:17]
    s_mov_b64 exec, vcc
    ds_write_b128 v11, v[16:19]
    s_mov_b64 exec, -1
    v_lshl_or_b32 v62, v0, 2, 0
    v_lshl_or_b32 v63, v0, 2, 1
    v_lshl_or_b32 v64, v0, 2, 2
    v_lshl_or_b32 v65, v0, 2, 3
    v_mov_b32 v11, 10923
    v_add_u32 v66, 2048, v0
    v_lshlrev_b32 v1, 4, v7
    s_waitcnt vmcnt(4)
    v_mul_u32_u24 v152, 214749, v120
    v_mul_u32_u24 v153, 214749, v121
    v_mul_u32_u24 v154, 214749, v122
    v_mul_u32_u24 v155, 214749, v123
    v_mul_u32_u24 v156, 214749, v124
    v_lshrrev_b32 v152, 21, v152
    v_lshrrev_b32 v153, 21, v153
    v_lshrrev_b32 v154, 21, v154
    v_lshrrev_b32 v155, 21, v155
    v_lshrrev_b32 v156, 21, v156
    v_and_b32 v136, -4, v152
    v_and_b32 v137, -4, v153
    v_and_b32 v138, -4, v154
    v_and_b32 v139, -4, v155
    v_and_b32 v140, -4, v156
    ds_add_rtn_u32 v144, v136, v11 offset:30976
    ds_add_rtn_u32 v145, v137, v11 offset:30976
    ds_add_rtn_u32 v146, v138, v11 offset:30976
    ds_add_rtn_u32 v147, v139, v11 offset:30976
    s_mov_b64 exec, s[44:45]
    ds_add_rtn_u32 v148, v140, v11 offset:30976
    s_mov_b64 exec, -1
    s_add_u32 m0, s43, 55552
    s_nop 0
    buffer_load_dwordx4 v[32:33], s[24:27], 0 idxen offen lds
    s_add_u32 m0, s43, 71936
    s_nop 0
    global_load_lds_dwordx4 v28, s[16:17]
    s_add_u32 m0, s43, 98560
    s_nop 0
    global_load_lds_dwordx4 v28, s[12:13]
    s_add_u32 m0, s43, 90368
    s_nop 0
    global_load_lds_dwordx4 v28, s[14:15]
    v_lshl_or_b32 v120, v120, 26, v62
    v_lshl_or_b32 v121, v121, 26, v63
    v_lshl_or_b32 v122, v122, 26, v64
    v_lshl_or_b32 v123, v123, 26, v65
    v_lshl_or_b32 v124, v124, 26, v66
    s_waitcnt lgkmcnt(0)
    s_barrier
    ds_read_b128 v[168:171], v1 offset:30976
    s_mov_b64 exec, 0xffff
    ds_read_b64 v[180:181], v14 offset:30976
    s_mov_b64 exec, -1
    s_mul_i32 s97, s97, 1664525
    s_add_u32 s97, s97, 1013904223
    s_mul_i32 s42, s2, 2176
    s_add_u32 s42, s42, 4161792
    s_waitcnt lgkmcnt(0)
    v_add_u32 v168, 21846, v168
    v_add_u32 v169, 21846, v169
    v_add_u32 v170, 21846, v170
    v_add_u32 v171, 21846, v171
    v_lshrrev_b32 v168, 15, v168
    v_lshrrev_b32 v169, 15, v169
    v_lshrrev_b32 v170, 15, v170
    v_lshrrev_b32 v171, 15, v171
    v_add_u32 v173, v168, v169
    v_add_u32 v174, v173, v170
    v_add_u32 v175, v174, v171
    v_mov_b32 v172, v175
    v_lshl_add_u32 v180, v180, 1, v180
    v_lshl_add_u32 v181, v181, 1, v181
    v_add_u32_dpp v172, v172, v172 row_shr:1 row_mask:0xf bank_mask:0xf bound_ctrl:0
    v_lshrrev_b32 v180, 15, v180
    v_lshrrev_b32 v181, 15, v181
    v_add_u32_dpp v172, v172, v172 row_shr:2 row_mask:0xf bank_mask:0xf bound_ctrl:0
    v_mov_b32 v169, s97
    v_mov_b32 v171, s97
    v_add_u32_dpp v172, v172, v172 row_shr:4 row_mask:0xf bank_mask:0xf bound_ctrl:0
    v_lshrrev_b32 v144, 13, v144
    v_lshrrev_b32 v145, 13, v145
    v_add_u32_dpp v172, v172, v172 row_shr:8 row_mask:0xf bank_mask:0xf bound_ctrl:0
    v_lshrrev_b32 v146, 13, v146
    v_lshrrev_b32 v147, 13, v147
    v_add_u32_dpp v172, v172, v172 row_bcast:15 row_mask:0xa bank_mask:0xf
    v_lshrrev_b32 v148, 13, v148
    s_nop 0
    v_add_u32_dpp v172, v172, v172 row_bcast:31 row_mask:0xc bank_mask:0xf
    v_sub_u32 v176, v172, v175
    v_readlane_b32 s3, v172, 63
    v_add_lshl_u32 v177, v176, v168, 2
    v_add_lshl_u32 v178, v176, v173, 2
    v_add_lshl_u32 v179, v176, v174, 2
    v_lshlrev_b32 v176, 2, v176
    ds_write_b128 v1, v[176:179] offset:33024
    ds_read_b32 v152, v136 offset:33024
    ds_read_b32 v153, v137 offset:33024
    ds_read_b32 v154, v138 offset:33024
    ds_read_b32 v155, v139 offset:33024
    ds_read_b32 v156, v140 offset:33024
    s_mov_b64 exec, 0xffff
    ds_read_b64 v[182:183], v14 offset:33024
    s_mov_b64 exec, -1
    s_add_u32 s3, s3, 7
    s_lshr_b32 s3, s3, 3
    v_cmp_gt_u32 vcc, s3, v15
    v_lshlrev_b32 v15, 1, v14
    s_waitcnt lgkmcnt(0)
    v_add_lshl_u32 v152, v152, v144, 2
    v_add_lshl_u32 v153, v153, v145, 2
    v_add_lshl_u32 v154, v154, v146, 2
    v_add_lshl_u32 v155, v155, v147, 2
    v_add_lshl_u32 v156, v156, v148, 2
    v_lshl_or_b32 v168, v180, 16, v182
    v_lshl_or_b32 v170, v181, 16, v183
    s_mov_b64 exec, 0xffff
    buffer_store_dwordx4 v[168:171], v15, s[36:39], s42 offen sc1
    s_mov_b64 exec, -1
    s_waitcnt vmcnt(7)
    v_lshl_or_b32 v120, v128, 12, v120
    v_lshl_or_b32 v121, v129, 12, v121
    v_lshl_or_b32 v122, v130, 12, v122
    v_lshl_or_b32 v123, v131, 12, v123
    v_lshl_or_b32 v124, v132, 12, v124
    ds_write_b32 v152, v120 offset:34048
    ds_write_b32 v153, v121 offset:34048
    ds_write_b32 v154, v122 offset:34048
    ds_write_b32 v155, v123 offset:34048
    s_mov_b64 exec, s[44:45]
    ds_write_b32 v156, v124 offset:34048
    s_mov_b64 exec, -1
    s_mul_i32 s3, s2, 16256
    s_add_u32 s3, s3, 256
    s_waitcnt lgkmcnt(0)
    s_barrier
    ds_read_b128 v[120:123], v23 offset:34048
    ds_read_b128 v[124:127], v31 offset:34048
    s_waitcnt lgkmcnt(1)
    v_mov_b32 v123, s97
    buffer_store_dwordx4 v[120:123], v23, s[36:39], s3 offen sc1
    s_waitcnt lgkmcnt(0)
    v_mov_b32 v127, s97
    s_mov_b64 exec, vcc
    buffer_store_dwordx4 v[124:127], v31, s[36:39], s3 offen sc1
    s_mov_b64 exec, -1
    s_mov_b32 s96, 0xbfb8aa3b
    v_add_u32 v30, 71936, v30
    v_add_u32 v31, 80128, v28
    s_waitcnt vmcnt(3)
    v_and_b32 v141, 0xffff0000, v160
    v_lshlrev_b32 v140, 16, v160
    v_and_b32 v143, 0xffff0000, v161
    v_lshlrev_b32 v142, 16, v161
    v_and_b32 v145, 0xffff0000, v162
    v_lshlrev_b32 v144, 16, v162
    v_and_b32 v147, 0xffff0000, v163
    v_lshlrev_b32 v146, 16, v163
    v_and_b32 v149, 0xffff0000, v164
    v_lshlrev_b32 v148, 16, v164
    v_and_b32 v151, 0xffff0000, v165
    v_lshlrev_b32 v150, 16, v165
    v_and_b32 v153, 0xffff0000, v166
    v_lshlrev_b32 v152, 16, v166
    v_and_b32 v155, 0xffff0000, v167
    v_lshlrev_b32 v154, 16, v167
    v_mul_f32 v140, s96, v140
    v_mul_f32 v141, s96, v141
    v_mul_f32 v142, s96, v142
    v_mul_f32 v143, s96, v143
    v_mul_f32 v144, s96, v144
    v_mul_f32 v145, s96, v145
    v_mul_f32 v146, s96, v146
    v_mul_f32 v147, s96, v147
    v_mul_f32 v148, s96, v148
    v_mul_f32 v149, s96, v149
    v_mul_f32 v150, s96, v150
    v_mul_f32 v151, s96, v151
    v_mul_f32 v152, s96, v152
    v_mul_f32 v153, s96, v153
    v_mul_f32 v154, s96, v154
    v_mul_f32 v155, s96, v155
    v_cvt_pk_bf16_f32 v160, v140, v141
    v_cvt_pk_bf16_f32 v161, v142, v143
    v_cvt_pk_bf16_f32 v162, v144, v145
    v_cvt_pk_bf16_f32 v163, v146, v147
    v_cvt_pk_bf16_f32 v164, v148, v149
    v_cvt_pk_bf16_f32 v165, v150, v151
    v_cvt_pk_bf16_f32 v166, v152, v153
    v_cvt_pk_bf16_f32 v167, v154, v155
    ds_write_b128 v31, v[160:163]
    s_mov_b64 exec, 0xffff
    ds_write_b128 v30, v[164:167]
    s_mov_b64 exec, -1
    s_waitcnt lgkmcnt(0)
    s_barrier
    ds_read_b128 v[104:107], v56
    ds_read_b64_tr_b16 v[72:73], v67 offset:0
    ds_read_b64_tr_b16 v[74:75], v67 offset:512
    ds_read_b128 v[108:111], v57
    ds_read_b64_tr_b16 v[76:77], v67 offset:2048
    ds_read_b64_tr_b16 v[78:79], v67 offset:2560
    ds_read_b128 v[112:115], v58
    ds_read_b64_tr_b16 v[80:81], v67 offset:4096
    ds_read_b64_tr_b16 v[82:83], v67 offset:4608
    ds_read_b128 v[116:119], v59
    ds_read_b64_tr_b16 v[84:85], v67 offset:6144
    ds_read_b64_tr_b16 v[86:87], v67 offset:6656
    v_and_b32 v7, 63, v0
    v_lshrrev_b32 v8, 1, v0
    s_lshl_b32 s3, s100, 3
    s_add_u32 s3, s3, 4161792
    v_mul_u32_u24 v3, 2176, v8
    v_add_u32 v3, s3, v3
    v_and_b32 v6, 1, v0
    v_mul_u32_u24 v9, 2500, v8
    v_mul_u32_u24 v2, 16256, v8
    v_lshl_add_u32 v2, v6, 4, v2
    v_mul_u32_u24 v6, 3, v6
    v_mov_b32 v123, s97
    v_mov_b32 v127, s97
    v_mov_b32 v131, s97
    v_mov_b32 v135, s97
    v_mov_b32 v139, s97
    v_and_b32 v14, 31, v7
    v_lshlrev_b32 v14, 3, v14
    v_mov_b32 v15, v14
    s_mul_i32 s43, s8, 24576
    v_add3_u32 v54, v54, s43, v14
    buffer_load_dwordx2 v[12:13], v3, s[36:39], 0 offen sc1
    s_waitcnt lgkmcnt(0)
    v_mfma_f32_32x32x16_bf16 v[88:103], v[104:107], v[72:75], 0
    ds_read_b64_tr_b16 v[184:185], v70 offset:8192
    ds_read_b64_tr_b16 v[186:187], v70 offset:8704
    ds_read_b64_tr_b16 v[188:189], v71 offset:8192
    v_mfma_f32_32x32x16_bf16 v[88:103], v[108:111], v[76:79], v[88:103]
    ds_read_b64_tr_b16 v[190:191], v71 offset:8704
    ds_read_b64_tr_b16 v[192:193], v70 offset:10240
    ds_read_b64_tr_b16 v[194:195], v70 offset:10752
    v_mfma_f32_32x32x16_bf16 v[88:103], v[112:115], v[80:83], v[88:103]
    ds_read_b64_tr_b16 v[196:197], v71 offset:10240
    ds_read_b64_tr_b16 v[198:199], v71 offset:10752
    ds_read_b64_tr_b16 v[200:201], v70 offset:12288
    v_mfma_f32_32x32x16_bf16 v[88:103], v[116:119], v[84:87], v[88:103]
    ds_read_b64_tr_b16 v[202:203], v70 offset:12800
    ds_read_b64_tr_b16 v[204:205], v71 offset:12288
    ds_read_b64_tr_b16 v[206:207], v71 offset:12800
    s_waitcnt lgkmcnt(4)
    ds_read_b64_tr_b16 v[208:209], v70 offset:14336
    ds_read_b64_tr_b16 v[210:211], v70 offset:14848
    ds_read_b64_tr_b16 v[212:213], v71 offset:14336
    ds_read_b64_tr_b16 v[214:215], v71 offset:14848
    ds_read_b64_tr_b16 v[216:217], v70 offset:16384
    ds_read_b64_tr_b16 v[218:219], v70 offset:16896
    ds_read_b64_tr_b16 v[220:221], v71 offset:16384
    ds_read_b64_tr_b16 v[222:223], v71 offset:16896
    s_waitcnt lgkmcnt(4)
    ds_read_b64_tr_b16 v[224:225], v70 offset:18432
    ds_read_b64_tr_b16 v[226:227], v70 offset:18944
    ds_read_b64_tr_b16 v[228:229], v71 offset:18432
    ds_read_b64_tr_b16 v[230:231], v71 offset:18944
    ds_read_b64_tr_b16 v[232:233], v70 offset:20480
    ds_read_b64_tr_b16 v[234:235], v70 offset:20992
    ds_read_b64_tr_b16 v[236:237], v71 offset:20480
    ds_read_b64_tr_b16 v[238:239], v71 offset:20992
    s_waitcnt lgkmcnt(4)
    ds_read_b64_tr_b16 v[240:241], v70 offset:22528
    ds_read_b64_tr_b16 v[242:243], v70 offset:23040
    ds_read_b64_tr_b16 v[244:245], v71 offset:22528
    ds_read_b64_tr_b16 v[246:247], v71 offset:23040
    ds_read_b64_tr_b16 v[248:249], v70 offset:24576
    ds_read_b64_tr_b16 v[250:251], v70 offset:25088
    ds_read_b64_tr_b16 v[252:253], v71 offset:24576
    ds_read_b64_tr_b16 v[254:255], v71 offset:25088
    s_mov_b32 s9, 0
    s_mov_b32 s10, 0x40000
    s_mov_b32 s101, 0
    s_mov_b64 s[44:45], s[20:21]
    s_mov_b32 s20, 30
    s_waitcnt vmcnt(0)
B_poll:
    v_cmpx_ne_u32 vcc, s97, v13
    s_cbranch_execz B_polled
    s_sub_u32 s10, s10, 1
    s_cbranch_scc1 B_nopoll
    buffer_load_dwordx2 v[12:13], v3, s[36:39], 0 offen sc1
    s_waitcnt vmcnt(0)
    s_branch B_poll
B_nopoll:
    s_mov_b32 s10, 0
    v_mov_b32 v12, 0
B_polled:
    s_mov_b64 exec, -1
    v_lshrrev_b32 v4, 16, v12
    v_and_b32 v1, 0xffff, v12
    v_lshl_add_u32 v1, v1, 2, v2
    v_sub_u32 v5, v4, v6
    v_cmpx_lt_i32 vcc, 0, v5
    buffer_load_dwordx4 v[120:123], v1, s[36:39], 0 offen offset:256
    v_cmpx_lt_i32 vcc, 6, v5
    buffer_load_dwordx4 v[124:127], v1, s[36:39], 0 offen offset:288
    v_cmpx_lt_i32 vcc, 12, v5
    buffer_load_dwordx4 v[128:131], v1, s[36:39], 0 offen offset:320
    v_cmpx_lt_i32 vcc, 18, v5
    buffer_load_dwordx4 v[132:135], v1, s[36:39], 0 offen offset:352
    v_cmpx_lt_i32 vcc, 24, v5
    buffer_load_dwordx4 v[136:139], v1, s[36:39], 0 offen offset:384
    s_mov_b64 exec, -1
    s_cmp_eq_u32 s8, 0
    s_cselect_b32 exec_hi, -1, 0
    s_cselect_b64 s[42:43], -1, 0
    s_cmp_eq_u32 s44, 0
    s_cbranch_scc1 B_xa
    s_lshl_b32 s45, s45, 8
    v_add_u32 v54, s45, v54
    s_mov_b64 exec, -1
    v_mov_b64 v[72:73], v[88:89]
    v_mov_b64 v[74:75], v[90:91]
    v_mov_b64 v[76:77], v[92:93]
    v_mov_b64 v[78:79], v[94:95]
    v_mov_b64 v[80:81], v[96:97]
    v_mov_b64 v[82:83], v[98:99]
    v_mov_b64 v[84:85], v[100:101]
    v_mov_b64 v[86:87], v[102:103]
    v_mov_b64 v[56:57], 0
    v_mov_b64 v[58:59], 0
    s_mul_i32 s3, s40, 7680
    s_sub_u32 s3, s3, 30464
    v_lshrrev_b32 v60, 5, v7
    v_mul_u32_u24 v60, 768, v60
    v_lshl_add_u32 v60, v14, 1, v60
    v_add_u32 v60, s3, v60
    s_waitcnt lgkmcnt(4)
    ds_write_b128 v60, v[56:59] offset:0
    ds_write_b128 v60, v[56:59] offset:1536
    ds_write_b128 v60, v[56:59] offset:3072
    ds_write_b128 v60, v[56:59] offset:4608
    ds_write_b128 v60, v[56:59] offset:6144
    s_branch B_xa_done
B_xa:
    s_lshl_b32 s45, s45, 2
    v_add_u32 v54, s45, v54
    v_mul_f32 v72, s96, v88
    v_mul_f32 v73, s96, v89
    v_mul_f32 v74, s96, v90
    v_mul_f32 v75, s96, v91
    v_mul_f32 v76, s96, v92
    v_mul_f32 v77, s96, v93
    v_mul_f32 v78, s96, v94
    v_mul_f32 v79, s96, v95
    v_mul_f32 v80, s96, v96
    v_mul_f32 v81, s96, v97
    v_mul_f32 v82, s96, v98
    v_mul_f32 v83, s96, v99
    v_mul_f32 v84, s96, v100
    v_mul_f32 v85, s96, v101
    v_mul_f32 v86, s96, v102
    v_mul_f32 v87, s96, v103
    v_exp_f32 v56, v72
    v_exp_f32 v57, v73
    v_exp_f32 v58, v74
    v_exp_f32 v59, v75
    v_exp_f32 v60, v76
    v_exp_f32 v61, v77
    v_exp_f32 v62, v78
    v_exp_f32 v63, v79
    v_exp_f32 v64, v80
    v_exp_f32 v65, v81
    v_exp_f32 v66, v82
    v_exp_f32 v67, v83
    v_exp_f32 v68, v84
    v_exp_f32 v69, v85
    v_exp_f32 v70, v86
    v_exp_f32 v71, v87
    v_max_f32 v88, |v72|, |v73|
    v_max3_f32 v88, |v74|, |v75|, v88
    v_max3_f32 v88, |v76|, |v77|, v88
    v_max3_f32 v88, |v78|, |v79|, v88
    v_max3_f32 v88, |v80|, |v81|, v88
    v_max3_f32 v88, |v82|, |v83|, v88
    v_max3_f32 v88, |v84|, |v85|, v88
    v_max3_f32 v88, |v86|, |v87|, v88
    v_cmp_lt_f32 vcc, 0x42700000, v88
    v_mov_b32 v89, 1
    v_mov_b32 v90, 119296
    s_waitcnt lgkmcnt(4)
    ds_write_b32 v54, v56 offset:0
    ds_write_b32 v54, v57 offset:768
    ds_write_b32 v54, v58 offset:1536
    ds_write_b32 v54, v59 offset:2304
    ds_write_b32 v54, v60 offset:3072
    ds_write_b32 v54, v61 offset:3840
    ds_write_b32 v54, v62 offset:4608
    ds_write_b32 v54, v63 offset:5376
    s_mov_b64 exec, s[42:43]
    s_waitcnt lgkmcnt(4)
    ds_write_b32 v54, v64 offset:6144
    ds_write_b32 v54, v65 offset:6912
    ds_write_b32 v54, v66 offset:7680
    ds_write_b32 v54, v67 offset:8448
    ds_write_b32 v54, v68 offset:9216
    ds_write_b32 v54, v69 offset:9984
    ds_write_b32 v54, v70 offset:10752
    ds_write_b32 v54, v71 offset:11520
    s_mov_b64 exec, vcc
    ds_write_b32 v90, v89
B_xa_done:
    s_mov_b64 exec, -1
    v_min_i32 v5, s20, v4
    v_sub_u32 v5, v5, v6
    v_cmp_lt_i32 s[46:47], s20, v4
    v_cmp_lt_i32 s[48:49], 0, v5
    v_cmp_lt_i32 s[50:51], 1, v5
    v_cmp_lt_i32 s[52:53], 2, v5
    v_cmp_lt_i32 s[54:55], 6, v5
    v_cmp_lt_i32 s[56:57], 7, v5
    v_cmp_lt_i32 s[58:59], 8, v5
    v_cmp_lt_i32 s[60:61], 12, v5
    v_cmp_lt_i32 s[62:63], 13, v5
    v_cmp_lt_i32 s[64:65], 14, v5
    v_cmp_lt_i32 s[66:67], 18, v5
    v_cmp_lt_i32 s[68:69], 19, v5
    v_cmp_lt_i32 s[70:71], 20, v5
    v_cmp_lt_i32 s[72:73], 24, v5
    v_cmp_lt_i32 s[74:75], 25, v5
    v_cmp_lt_i32 s[76:77], 26, v5
    v_mul_u32_u24 v10, 43, v7
    v_lshrrev_b32 v10, 9, v10
    v_mul_u32_u24 v11, 12, v10
    v_sub_u32 v11, v7, v11
    s_mul_i32 s3, s40, 5
    v_add_u32 v10, s3, v10
    v_cmp_gt_u32 vcc, 60, v7
    v_lshlrev_b32 v22, 3, v11
    v_add_u32 v22, 112896, v22
    v_cndmask_b32 v10, 50, v10, vcc
    v_lshlrev_b32 v20, 2, v10
    v_add_u32 v20, 55552, v20
    v_mul_u32_u24 v173, 768, v10
    v_lshlrev_b32 v21, 6, v11
    v_lshl_add_u32 v172, v10, 10, v21
    v_add_u32 v172, 119424, v172
    s_lshl_b32 s42, s40, 5
    s_cmp_lt_u32 s40, 4
    s_mov_b32 s3, 112768
    s_cselect_b32 s3, s3, 113024
    s_add_u32 s42, s42, s3
    v_lshrrev_b32 v10, 5, v7
    v_lshl_add_u32 v34, v10, 4, s42
    v_lshrrev_b32 v10, 4, v7
    v_lshl_add_u32 v35, v10, 3, s42
    s_mov_b32 s28, s6
    s_and_b32 s29, s7, 0xffff
    s_or_b32 s29, s29, 2097152
    s_mov_b32 s30, 640000
    s_mov_b32 s31, 0x20000
    s_mov_b32 s32, s18
    s_and_b32 s33, s19, 0xffff
    s_mov_b32 s34, 1280000
    s_mov_b32 s35, 0x20000
    s_movk_i32 s78, 0xfc
    s_lshl_b32 s11, s80, 26
    s_movk_i32 s12, 512
    s_movk_i32 s13, 512
    s_mov_b32 s98, 1.0
    s_mov_b32 s99, 1.0
    v_xor_b32 v45, 16, v43
    v_xor_b32 v47, 32, v43
    v_xor_b32 v49, 48, v43
    v_add_u32 v43, 3072, v43
    v_add_u32 v45, 2048, v45
    v_add_u32 v47, 1024, v47
    s_sub_u32 s24, s24, 3072
    s_subb_u32 s25, s25, 0
    v_and_b32 v26, 8, v7
    v_and_b32 v27, 14, v7
    v_lshl_or_b32 v27, v27, 2, 4
    v_lshrrev_b32 v11, 4, v7
    v_xor_b32 v11, v7, v11
    v_and_b32 v11, 1, v11
    v_lshlrev_b32 v51, 4, v11
    s_waitcnt vmcnt(0) lgkmcnt(2)
B_verify:
    v_min3_u32 v10, v123, v127, v131
    v_max3_u32 v11, v123, v127, v131
    v_min3_u32 v10, v135, v139, v10
    v_max3_u32 v11, v135, v139, v11
    v_cmp_ne_u32 vcc, s97, v10
    v_cmp_ne_u32 s[42:43], s97, v11
    s_or_b64 exec, vcc, s[42:43]
    s_cbranch_scc0 B_sort
    s_sub_u32 s10, s10, 1
    s_cbranch_scc1 B_giveup
    v_sub_u32 v5, v4, v6
    v_cmpx_lt_i32 vcc, 0, v5
    buffer_load_dwordx4 v[120:123], v1, s[36:39], 0 offen offset:256 sc1
    v_cmpx_lt_i32 vcc, 6, v5
    buffer_load_dwordx4 v[124:127], v1, s[36:39], 0 offen offset:288 sc1
    v_cmpx_lt_i32 vcc, 12, v5
    buffer_load_dwordx4 v[128:131], v1, s[36:39], 0 offen offset:320 sc1
    v_cmpx_lt_i32 vcc, 18, v5
    buffer_load_dwordx4 v[132:135], v1, s[36:39], 0 offen offset:352 sc1
    v_cmpx_lt_i32 vcc, 24, v5
    buffer_load_dwordx4 v[136:139], v1, s[36:39], 0 offen offset:384 sc1
    s_mov_b64 exec, -1
    s_waitcnt vmcnt(0)
    s_branch B_verify
B_sort:
    s_mov_b64 exec, -1
    v_subrev_u32 v120, s11, v120
    v_subrev_u32 v121, s11, v121
    v_subrev_u32 v122, s11, v122
    v_subrev_u32 v124, s11, v124
    v_subrev_u32 v125, s11, v125
    v_subrev_u32 v126, s11, v126
    v_subrev_u32 v128, s11, v128
    v_subrev_u32 v129, s11, v129
    v_subrev_u32 v130, s11, v130
    v_subrev_u32 v132, s11, v132
    v_subrev_u32 v133, s11, v133
    v_subrev_u32 v134, s11, v134
    v_and_b32_sdwa v140, s78, v120 dst_sel:DWORD dst_unused:UNUSED_PAD src0_sel:DWORD src1_sel:BYTE_3
    v_and_b32_sdwa v141, s78, v121 dst_sel:DWORD dst_unused:UNUSED_PAD src0_sel:DWORD src1_sel:BYTE_3
    v_and_b32_sdwa v142, s78, v122 dst_sel:DWORD dst_unused:UNUSED_PAD src0_sel:DWORD src1_sel:BYTE_3
    v_and_b32_sdwa v143, s78, v124 dst_sel:DWORD dst_unused:UNUSED_PAD src0_sel:DWORD src1_sel:BYTE_3
    v_and_b32_sdwa v144, s78, v125 dst_sel:DWORD dst_unused:UNUSED_PAD src0_sel:DWORD src1_sel:BYTE_3
    v_and_b32_sdwa v145, s78, v126 dst_sel:DWORD dst_unused:UNUSED_PAD src0_sel:DWORD src1_sel:BYTE_3
    v_and_b32_sdwa v146, s78, v128 dst_sel:DWORD dst_unused:UNUSED_PAD src0_sel:DWORD src1_sel:BYTE_3
    v_and_b32_sdwa v147, s78, v129 dst_sel:DWORD dst_unused:UNUSED_PAD src0_sel:DWORD src1_sel:BYTE_3
    v_and_b32_sdwa v148, s78, v130 dst_sel:DWORD dst_unused:UNUSED_PAD src0_sel:DWORD src1_sel:BYTE_3
    v_and_b32_sdwa v149, s78, v132 dst_sel:DWORD dst_unused:UNUSED_PAD src0_sel:DWORD src1_sel:BYTE_3
    v_and_b32_sdwa v150, s78, v133 dst_sel:DWORD dst_unused:UNUSED_PAD src0_sel:DWORD src1_sel:BYTE_3
    v_and_b32_sdwa v151, s78, v134 dst_sel:DWORD dst_unused:UNUSED_PAD src0_sel:DWORD src1_sel:BYTE_3
    v_cmp_gt_u32 s[14:15], 16, v140
    v_cmp_gt_u32 s[16:17], 16, v141
    v_cmp_gt_u32 s[18:19], 16, v142
    v_cmp_gt_u32 s[42:43], 16, v143
    v_cmp_gt_u32 s[44:45], 16, v144
    v_cmp_gt_u32 s[6:7], 16, v145
    v_cmp_gt_u32 vcc, 16, v146
    v_and_b32 v89, 0xfff, v120
    v_add_u32 v89, v89, v9
    v_and_b32 v91, 0xfff, v121
    v_add_u32 v91, v91, v9
    v_and_b32 v93, 0xfff, v122
    v_add_u32 v93, v93, v9
    v_and_b32 v95, 0xfff, v124
    v_add_u32 v95, v95, v9
    v_and_b32 v97, 0xfff, v125
    v_add_u32 v97, v97, v9
    v_and_b32 v99, 0xfff, v126
    v_add_u32 v99, v99, v9
    v_and_b32 v101, 0xfff, v128
    v_add_u32 v101, v101, v9
    s_and_b64 exec, s[14:15], s[48:49]
    buffer_load_dword v53, v89, s[28:31], 0 idxen
    s_and_b64 exec, s[16:17], s[50:51]
    buffer_load_dword v53, v91, s[28:31], 0 idxen
    s_and_b64 exec, s[18:19], s[52:53]
    buffer_load_dword v53, v93, s[28:31], 0 idxen
    s_and_b64 exec, s[42:43], s[54:55]
    buffer_load_dword v53, v95, s[28:31], 0 idxen
    s_and_b64 exec, s[44:45], s[56:57]
    buffer_load_dword v53, v97, s[28:31], 0 idxen
    s_and_b64 exec, s[6:7], s[58:59]
    buffer_load_dword v53, v99, s[28:31], 0 idxen
    s_and_b64 exec, vcc, s[60:61]
    buffer_load_dword v53, v101, s[28:31], 0 idxen
    s_mov_b64 exec, -1
B_count:
    v_mov_b32 v11, 8
    s_mov_b64 exec, s[48:49]
    ds_add_rtn_u32 v156, v140, v11 offset:30720
    s_mov_b64 exec, s[50:51]
    ds_add_rtn_u32 v157, v141, v11 offset:30720
    s_mov_b64 exec, s[52:53]
    ds_add_rtn_u32 v158, v142, v11 offset:30720
    s_mov_b64 exec, s[54:55]
    ds_add_rtn_u32 v159, v143, v11 offset:30720
    s_mov_b64 exec, s[56:57]
    ds_add_rtn_u32 v160, v144, v11 offset:30720
    s_mov_b64 exec, s[58:59]
    ds_add_rtn_u32 v161, v145, v11 offset:30720
    s_mov_b64 exec, s[60:61]
    ds_add_rtn_u32 v162, v146, v11 offset:30720
    s_mov_b64 exec, s[62:63]
    ds_add_rtn_u32 v163, v147, v11 offset:30720
    s_mov_b64 exec, s[64:65]
    ds_add_rtn_u32 v164, v148, v11 offset:30720
    s_mov_b64 exec, s[66:67]
    ds_add_rtn_u32 v165, v149, v11 offset:30720
    s_mov_b64 exec, s[68:69]
    ds_add_rtn_u32 v166, v150, v11 offset:30720
    s_mov_b64 exec, s[70:71]
    ds_add_rtn_u32 v167, v151, v11 offset:30720
    s_mov_b64 exec, -1
    v_bfe_u32 v88, v120, 12, 14
    v_bfe_u32 v90, v121, 12, 14
    v_bfe_u32 v92, v122, 12, 14
    v_bfe_u32 v94, v124, 12, 14
    v_bfe_u32 v96, v125, 12, 14
    v_bfe_u32 v98, v126, 12, 14
    v_bfe_u32 v100, v128, 12, 14
    v_and_b32 v103, 0xfff, v129
    v_add_u32 v103, v103, v9
    v_bfe_u32 v102, v129, 12, 14
    v_and_b32 v105, 0xfff, v130
    v_add_u32 v105, v105, v9
    v_bfe_u32 v104, v130, 12, 14
    v_and_b32 v107, 0xfff, v132
    v_add_u32 v107, v107, v9
    v_bfe_u32 v106, v132, 12, 14
    v_and_b32 v109, 0xfff, v133
    v_add_u32 v109, v109, v9
    v_bfe_u32 v108, v133, 12, 14
    v_and_b32 v111, 0xfff, v134
    v_add_u32 v111, v111, v9
    v_bfe_u32 v110, v134, 12, 14
    v_mov_b32 v10, 119424
    s_waitcnt lgkmcnt(6)
    v_lshl_add_u32 v56, v140, 8, v156
    v_lshl_add_u32 v57, v141, 8, v157
    v_lshl_add_u32 v58, v142, 8, v158
    v_lshl_add_u32 v59, v143, 8, v159
    v_lshl_add_u32 v60, v144, 8, v160
    v_lshl_add_u32 v61, v145, 8, v161
    v_add_u32 v56, v10, v56
    v_add_u32 v57, v10, v57
    v_add_u32 v58, v10, v58
    v_add_u32 v59, v10, v59
    v_add_u32 v60, v10, v60
    v_add_u32 v61, v10, v61
    s_mov_b64 exec, s[48:49]
    ds_write_b64 v56, v[88:89]
    s_mov_b64 exec, s[50:51]
    ds_write_b64 v57, v[90:91]
    s_mov_b64 exec, s[52:53]
    ds_write_b64 v58, v[92:93]
    s_mov_b64 exec, s[54:55]
    ds_write_b64 v59, v[94:95]
    s_mov_b64 exec, s[56:57]
    ds_write_b64 v60, v[96:97]
    s_mov_b64 exec, s[58:59]
    ds_write_b64 v61, v[98:99]
    s_waitcnt lgkmcnt(6)
    v_lshl_add_u32 v62, v146, 8, v162
    v_lshl_add_u32 v63, v147, 8, v163
    v_lshl_add_u32 v64, v148, 8, v164
    v_lshl_add_u32 v65, v149, 8, v165
    v_lshl_add_u32 v66, v150, 8, v166
    v_lshl_add_u32 v67, v151, 8, v167
    v_add_u32 v62, v10, v62
    v_add_u32 v63, v10, v63
    v_add_u32 v64, v10, v64
    v_add_u32 v65, v10, v65
    v_add_u32 v66, v10, v66
    v_add_u32 v67, v10, v67
    s_mov_b64 exec, s[60:61]
    ds_write_b64 v62, v[100:101]
    s_mov_b64 exec, s[62:63]
    ds_write_b64 v63, v[102:103]
    s_mov_b64 exec, s[64:65]
    ds_write_b64 v64, v[104:105]
    s_mov_b64 exec, s[66:67]
    ds_write_b64 v65, v[106:107]
    s_mov_b64 exec, s[68:69]
    ds_write_b64 v66, v[108:109]
    s_mov_b64 exec, s[70:71]
    ds_write_b64 v67, v[110:111]
    s_mov_b64 exec, -1
    s_or_b64 vcc, s[46:47], s[72:73]
    s_cbranch_scc1 B_p1x
B_p1done:
    v_lshlrev_b32 v10, 2, v7
    v_mov_b32 v24, 119296
    v_add_u32 v25, 55552, v10
    s_waitcnt lgkmcnt(0)
    s_barrier
    ds_read_b32 v12, v10 offset:30720
    ds_read_b64 v[18:19], v24
    s_waitcnt lgkmcnt(0)
    v_add_u32 v13, 56, v12
    v_lshrrev_b32 v13, 3, v13
    v_and_b32 v13, -8, v13
    v_mov_b32 v1, v13
    v_readfirstlane_b32 s5, v19
    v_readfirstlane_b32 s3, v18
    v_add_u32_dpp v1, v1, v1 row_shr:1 row_mask:0xf bank_mask:0xf bound_ctrl:0
    v_cmp_lt_u32 vcc, 1024, v12
    v_mov_b64 v[32:33], v[14:15]
    v_add_u32_dpp v1, v1, v1 row_shr:2 row_mask:0xf bank_mask:0xf bound_ctrl:0
    s_nop 1
    v_add_u32_dpp v1, v1, v1 row_shr:4 row_mask:0xf bank_mask:0xf bound_ctrl:0
    s_nop 1
    v_add_u32_dpp v1, v1, v1 row_shr:8 row_mask:0xf bank_mask:0xf bound_ctrl:0
    s_nop 1
    v_add_u32_dpp v1, v1, v1 row_bcast:15 row_mask:0xa bank_mask:0xf
    s_nop 1
    v_add_u32_dpp v1, v1, v1 row_bcast:31 row_mask:0xc bank_mask:0xf
    v_sub_u32 v13, v1, v13
    v_readlane_b32 s4, v1, 63
    ds_write2_b32 v25, v13, v1 offset1:1
    ds_read2_b32 v[16:17], v20 offset1:1
    s_or_b32 s9, s9, s3
    s_cbranch_vccnz B_compact
B_groups:
    s_add_u32 s21, s4, 31
    s_lshr_b32 s21, s21, 5
    s_min_u32 s3, s21, 4
    s_add_u32 s21, s21, 11
    s_sub_u32 s21, s21, s40
    s_lshr_b32 s21, s21, 3
    s_max_u32 s21, s21, 1
    s_cmp_ge_u32 s40, s3
    s_subb_u32 s21, s21, 0
    s_waitcnt lgkmcnt(0)
    v_add_u32 v16, v16, v22
    v_add_u32 v17, 112896, v17
    v_add_u32 v18, 96, v16
    v_cmp_lt_u32 s[42:43], v18, v17
    v_cmpx_lt_u32 vcc, v16, v17
    ds_write_b64 v16, v[172:173]
    s_mov_b64 exec, -1
    s_or_b32 s3, s42, s43
    s_or_b32 s3, s3, s9
    s_cbranch_scc1 B_p2x
B_p2done:
    s_cmp_gt_u32 s40, 3
    s_waitcnt lgkmcnt(0)
    s_barrier
    s_cbranch_scc1 B_young
    s_sub_u32 s21, s21, 1
    s_cbranch_scc1 B_loop_done
    s_setprio 3
    ds_read2_b32 v[72:73], v35 offset0:32 offset1:32
    ds_read2_b32 v[74:75], v35 offset0:64 offset1:64
    ds_read2_b32 v[76:77], v35 offset0:128 offset1:128
    ds_read2_b32 v[30:31], v34 offset0:33 offset1:35
    v_mov_b64 v[16:17], 0
    v_mov_b64 v[18:19], 0
    v_mov_b64 v[20:21], 0
    v_mov_b64 v[22:23], 0
    s_waitcnt lgkmcnt(3)
    v_lshl_add_u64 v[24:25], v[72:73], 0, v[26:27]
    ds_read_b32 v50, v25
    ds_read_b32 v42, v24 offset:0
    ds_read_b32 v44, v24 offset:16
    ds_read_b32 v46, v24 offset:32
    ds_read_b32 v48, v24 offset:48
    v_add_u32 v35, 768, v35
    s_waitcnt lgkmcnt(0)
    v_lshl_add_u64 v[24:25], v[74:75], 0, v[26:27]
    v_lshl_add_u64 v[30:31], v[30:31], 0, v[14:15]
    s_add_u32 m0, s41, 45056
    s_nop 0
    buffer_load_dwordx4 v[50:51], s[28:31], 0 idxen offen lds
    ds_read_b32 v50, v25
    s_add_u32 m0, s41, 40960
    s_nop 0
    buffer_load_dwordx4 v[42:43], s[24:27], 0 idxen offen offset:0 lds
    ds_read_b32 v42, v24 offset:0
    buffer_load_dwordx4 v[44:45], s[24:27], 0 idxen offen offset:1024 lds
    ds_read_b32 v44, v24 offset:16
    buffer_load_dwordx4 v[46:47], s[24:27], 0 idxen offen offset:2048 lds
    ds_read_b32 v46, v24 offset:32
    buffer_load_dwordx4 v[48:49], s[24:27], 0 idxen offen offset:3072 lds
    ds_read_b32 v48, v24 offset:48
    v_lshl_add_u64 v[24:25], v[76:77], 0, v[26:27]
    s_waitcnt lgkmcnt(0)
    s_add_u32 m0, s41, 4096
    s_nop 0
    buffer_load_dwordx4 v[50:51], s[28:31], 0 idxen offen lds
    s_add_u32 m0, s41, 0
    s_nop 0
    buffer_load_dwordx4 v[42:43], s[24:27], 0 idxen offen offset:0 lds
    buffer_load_dwordx4 v[44:45], s[24:27], 0 idxen offen offset:1024 lds
    buffer_load_dwordx4 v[46:47], s[24:27], 0 idxen offen offset:2048 lds
    buffer_load_dwordx4 v[48:49], s[24:27], 0 idxen offen offset:3072 lds
    s_setprio 0
    ds_read_b32 v50, v25
    ds_read_b32 v42, v24 offset:0
    ds_read_b32 v44, v24 offset:16
    ds_read_b32 v46, v24 offset:32
    ds_read_b32 v48, v24 offset:48
    ds_read2_b32 v[4:5], v30 offset0:0 offset1:0
    ds_read2_b32 v[6:7], v30 offset0:1 offset1:1
    ds_read2_b32 v[8:9], v31 offset0:0 offset1:0
    ds_read2_b32 v[10:11], v31 offset0:1 offset1:1
    s_waitcnt vmcnt(5)
    ds_read_b128 v[56:59], v38 offset:40960
    ds_read_b128 v[60:63], v39 offset:40960
    ds_read_b128 v[64:67], v40 offset:40960
    ds_read_b128 v[68:71], v41 offset:40960
    ds_read_b128 v[52:55], v37 offset:40960
    s_waitcnt lgkmcnt(0)
    v_mfma_f32_32x32x16_bf16 v[120:135], v[52:55], v[216:219], 0
    v_mfma_f32_32x32x16_bf16 v[136:151], v[52:55], v[220:223], 0
    v_mfma_f32_32x32x16_bf16 v[120:135], v[56:59], v[184:187], v[120:135]
    v_mfma_f32_32x32x16_bf16 v[136:151], v[56:59], v[188:191], v[136:151]
    v_mfma_f32_32x32x16_bf16 v[120:135], v[60:63], v[192:195], v[120:135]
    v_mfma_f32_32x32x16_bf16 v[136:151], v[60:63], v[196:199], v[136:151]
    v_mfma_f32_32x32x16_bf16 v[120:135], v[64:67], v[200:203], v[120:135]
    v_mfma_f32_32x32x16_bf16 v[136:151], v[64:67], v[204:207], v[136:151]
    v_mfma_f32_32x32x16_bf16 v[120:135], v[68:71], v[208:211], v[120:135]
    v_mfma_f32_32x32x16_bf16 v[136:151], v[68:71], v[212:215], v[136:151]
    s_nop 6
    s_branch B_z0done
B_young:
    s_cmp_lg_u32 s101, 0
    s_cbranch_scc1 B_xu_done
    s_cmp_lg_u32 s2, 0
    s_cbranch_scc1 B_nogen
    v_mov_b32 v120, s97
    s_mov_b64 exec, 1
    buffer_store_dword v120, off, s[36:39], 0 offset:0 sc1
    s_mov_b64 exec, -1
B_nogen:
    v_cvt_f64_f32 v[88:89], v72
    v_cvt_f64_f32 v[90:91], v73
    v_cvt_f64_f32 v[92:93], v74
    v_cvt_f64_f32 v[94:95], v75
    v_cvt_f64_f32 v[96:97], v76
    v_cvt_f64_f32 v[98:99], v77
    v_cvt_f64_f32 v[100:101], v78
    v_cvt_f64_f32 v[102:103], v79
    v_cvt_f64_f32 v[104:105], v80
    v_cvt_f64_f32 v[106:107], v81
    v_cvt_f64_f32 v[108:109], v82
    v_cvt_f64_f32 v[110:111], v83
    v_cvt_f64_f32 v[112:113], v84
    v_cvt_f64_f32 v[114:115], v85
    v_cvt_f64_f32 v[116:117], v86
    v_cvt_f64_f32 v[118:119], v87
    s_cmp_eq_u32 s8, 0
    s_cselect_b32 exec_hi, -1, 0
    s_cselect_b64 s[42:43], -1, 0
    ds_add_f64 v54, v[88:89] offset:256
    ds_add_f64 v54, v[90:91] offset:1024
    ds_add_f64 v54, v[92:93] offset:1792
    ds_add_f64 v54, v[94:95] offset:2560
    ds_add_f64 v54, v[96:97] offset:3328
    ds_add_f64 v54, v[98:99] offset:4096
    ds_add_f64 v54, v[100:101] offset:4864
    ds_add_f64 v54, v[102:103] offset:5632
    s_mov_b64 exec, s[42:43]
    s_waitcnt lgkmcnt(4)
    ds_add_f64 v54, v[104:105] offset:6400
    ds_add_f64 v54, v[106:107] offset:7168
    ds_add_f64 v54, v[108:109] offset:7936
    ds_add_f64 v54, v[110:111] offset:8704
    ds_add_f64 v54, v[112:113] offset:9472
    ds_add_f64 v54, v[114:115] offset:10240
    ds_add_f64 v54, v[116:117] offset:11008
    ds_add_f64 v54, v[118:119] offset:11776
    s_mov_b64 exec, -1
    s_waitcnt lgkmcnt(0)
B_xu_done:
    s_sub_u32 s21, s21, 1
    s_cbranch_scc1 B_loop_done
    ds_read2_b32 v[72:73], v35 offset0:0 offset1:0
    ds_read2_b32 v[74:75], v35 offset0:64 offset1:64
    ds_read2_b32 v[76:77], v35 offset0:128 offset1:128
    ds_read2_b32 v[30:31], v34 offset0:1 offset1:3
    v_mov_b64 v[16:17], 0
    v_mov_b64 v[18:19], 0
    v_mov_b64 v[20:21], 0
    v_mov_b64 v[22:23], 0
    s_waitcnt lgkmcnt(3)
    v_lshl_add_u64 v[24:25], v[72:73], 0, v[26:27]
    ds_read_b32 v50, v25
    ds_read_b32 v42, v24 offset:0
    ds_read_b32 v44, v24 offset:16
    ds_read_b32 v46, v24 offset:32
    ds_read_b32 v48, v24 offset:48
    v_add_u32 v35, 768, v35
    s_waitcnt lgkmcnt(0)
    v_lshl_add_u64 v[24:25], v[74:75], 0, v[26:27]
    v_lshl_add_u64 v[30:31], v[30:31], 0, v[14:15]
    s_add_u32 m0, s41, 4096
    s_nop 0
    buffer_load_dwordx4 v[50:51], s[28:31], 0 idxen offen lds
    s_add_u32 m0, s41, 0
    s_nop 0
    buffer_load_dwordx4 v[42:43], s[24:27], 0 idxen offen offset:0 lds
    buffer_load_dwordx4 v[44:45], s[24:27], 0 idxen offen offset:1024 lds
    buffer_load_dwordx4 v[46:47], s[24:27], 0 idxen offen offset:2048 lds
    buffer_load_dwordx4 v[48:49], s[24:27], 0 idxen offen offset:3072 lds
    s_setprio 0
    ds_read_b32 v50, v25
    ds_read_b32 v42, v24 offset:0
    ds_read_b32 v44, v24 offset:16
    ds_read_b32 v46, v24 offset:32
    ds_read_b32 v48, v24 offset:48
    ds_read2_b32 v[4:5], v30 offset0:0 offset1:0
    ds_read2_b32 v[6:7], v30 offset0:1 offset1:1
    ds_read2_b32 v[8:9], v31 offset0:0 offset1:0
    ds_read2_b32 v[10:11], v31 offset0:1 offset1:1
    v_lshl_add_u64 v[24:25], v[76:77], 0, v[26:27]
    s_waitcnt vmcnt(0)
    ds_read_b128 v[56:59], v38 offset:0
    ds_read_b128 v[60:63], v39 offset:0
    ds_read_b128 v[64:67], v40 offset:0
    ds_read_b128 v[68:71], v41 offset:0
    ds_read_b128 v[52:55], v37 offset:0
    s_waitcnt lgkmcnt(0)
    v_mfma_f32_32x32x16_bf16 v[120:135], v[52:55], v[216:219], 0
    s_add_u32 m0, s41, 4096
    v_mfma_f32_32x32x16_bf16 v[136:151], v[52:55], v[220:223], 0
    buffer_load_dwordx4 v[50:51], s[28:31], 0 idxen offen lds
    v_mfma_f32_32x32x16_bf16 v[120:135], v[56:59], v[184:187], v[120:135]
    s_add_u32 m0, s41, 0
    v_mfma_f32_32x32x16_bf16 v[136:151], v[56:59], v[188:191], v[136:151]
    buffer_load_dwordx4 v[42:43], s[24:27], 0 idxen offen offset:0 lds
    v_mfma_f32_32x32x16_bf16 v[120:135], v[60:63], v[192:195], v[120:135]
    v_mfma_f32_32x32x16_bf16 v[136:151], v[60:63], v[196:199], v[136:151]
    buffer_load_dwordx4 v[44:45], s[24:27], 0 idxen offen offset:1024 lds
    v_mfma_f32_32x32x16_bf16 v[120:135], v[64:67], v[200:203], v[120:135]
    v_mfma_f32_32x32x16_bf16 v[136:151], v[64:67], v[204:207], v[136:151]
    buffer_load_dwordx4 v[46:47], s[24:27], 0 idxen offen offset:2048 lds
    v_mfma_f32_32x32x16_bf16 v[120:135], v[68:71], v[208:211], v[120:135]
    v_mfma_f32_32x32x16_bf16 v[136:151], v[68:71], v[212:215], v[136:151]
    buffer_load_dwordx4 v[48:49], s[24:27], 0 idxen offen offset:3072 lds
    s_setprio 0
    ds_read_b32 v50, v25
    ds_read_b32 v42, v24 offset:0
    ds_read_b32 v44, v24 offset:16
    ds_read_b32 v46, v24 offset:32
    ds_read_b32 v48, v24 offset:48
B_z0done:
    s_cmp_lg_u32 s9, 0
    s_cbranch_scc1 B_slow
    v_mfma_f32_32x32x16_bf16 v[88:103], v[56:59], v[224:227], 0
    v_mfma_f32_32x32x16_bf16 v[104:119], v[56:59], v[228:231], 0
    s_nop 1
    v_mfma_f32_32x32x16_bf16 v[88:103], v[60:63], v[232:235], v[88:103]
    v_exp_f32 v120, v120
    v_exp_f32 v121, v121
    v_exp_f32 v122, v122
    v_mfma_f32_32x32x16_bf16 v[104:119], v[60:63], v[236:239], v[104:119]
    v_exp_f32 v123, v123
    v_exp_f32 v124, v124
    v_exp_f32 v125, v125
    v_mfma_f32_32x32x16_bf16 v[88:103], v[64:67], v[240:243], v[88:103]
    v_exp_f32 v126, v126
    v_exp_f32 v127, v127
    v_exp_f32 v128, v128
    v_mfma_f32_32x32x16_bf16 v[104:119], v[64:67], v[244:247], v[104:119]
    v_exp_f32 v129, v129
    v_exp_f32 v130, v130
    v_exp_f32 v131, v131
    v_mfma_f32_32x32x16_bf16 v[88:103], v[68:71], v[248:251], v[88:103]
    v_exp_f32 v132, v132
    v_exp_f32 v133, v133
    v_exp_f32 v134, v134
    v_mfma_f32_32x32x16_bf16 v[104:119], v[68:71], v[252:255], v[104:119]
    v_exp_f32 v135, v135
    v_exp_f32 v136, v136
    v_exp_f32 v137, v137
    v_exp_f32 v138, v138
    v_exp_f32 v139, v139
    v_exp_f32 v140, v140
    v_exp_f32 v141, v141
    v_exp_f32 v142, v142
    v_exp_f32 v143, v143
    v_exp_f32 v144, v144
    v_exp_f32 v145, v145
    v_exp_f32 v146, v146
    v_exp_f32 v147, v147
    v_exp_f32 v148, v148
    v_exp_f32 v149, v149
    v_exp_f32 v150, v150
    v_exp_f32 v151, v151
F_loop:
    s_sub_u32 s21, s21, 1
    s_cbranch_scc1 B_tail0
    s_setprio 0
    s_waitcnt vmcnt(0) lgkmcnt(0)
    ds_read_b128 v[56:59], v38 offset:0
    ds_read_b128 v[60:63], v39 offset:0
    ds_read_b128 v[64:67], v40 offset:0
    ds_read_b128 v[68:71], v41 offset:0
    ds_read_b128 v[52:55], v37 offset:0
    ds_add_f64 v32, v[16:17] offset:256
    ds_add_f64 v33, v[18:19] offset:256
    ds_add_f64 v32, v[20:21] offset:512
    ds_add_f64 v33, v[22:23] offset:512
    ds_read2_b32 v[28:29], v34 offset0:65 offset1:67
    ds_read2_b32 v[72:73], v35 offset0:0 offset1:0
.p2align 3
    v_pk_fma_f32 v[120:121], v[120:121], v[4:5], s[98:99]
    v_pk_fma_f32 v[122:123], v[122:123], v[4:5], s[98:99]
    v_pk_fma_f32 v[124:125], v[124:125], v[4:5], s[98:99]
    v_pk_fma_f32 v[126:127], v[126:127], v[4:5], s[98:99]
    v_pk_fma_f32 v[128:129], v[128:129], v[8:9], s[98:99]
    v_pk_fma_f32 v[130:131], v[130:131], v[8:9], s[98:99]
    v_pk_fma_f32 v[132:133], v[132:133], v[8:9], s[98:99]
    v_pk_fma_f32 v[134:135], v[134:135], v[8:9], s[98:99]
    v_pk_fma_f32 v[136:137], v[136:137], v[6:7], s[98:99]
    v_pk_fma_f32 v[138:139], v[138:139], v[6:7], s[98:99]
    v_pk_fma_f32 v[140:141], v[140:141], v[6:7], s[98:99]
    v_pk_fma_f32 v[142:143], v[142:143], v[6:7], s[98:99]
    v_pk_fma_f32 v[144:145], v[144:145], v[10:11], s[98:99]
    v_pk_fma_f32 v[146:147], v[146:147], v[10:11], s[98:99]
    v_pk_fma_f32 v[148:149], v[148:149], v[10:11], s[98:99]
    v_pk_fma_f32 v[150:151], v[150:151], v[10:11], s[98:99]
    s_waitcnt lgkmcnt(0)
    v_mfma_f32_32x32x16_bf16 v[152:167], v[56:59], v[184:187], 0
    s_setprio 1
    v_rcp_f32 v120, v120
    v_rcp_f32 v121, v121
    v_rcp_f32 v122, v122
    v_mfma_f32_32x32x16_bf16 v[168:183], v[56:59], v[188:191], 0
    v_rcp_f32 v123, v123
    v_rcp_f32 v124, v124
    v_rcp_f32 v125, v125
    v_mfma_f32_32x32x16_bf16 v[152:167], v[60:63], v[192:195], v[152:167]
    v_rcp_f32 v126, v126
    v_rcp_f32 v127, v127
    v_rcp_f32 v128, v128
    v_mfma_f32_32x32x16_bf16 v[168:183], v[60:63], v[196:199], v[168:183]
    v_rcp_f32 v129, v129
    v_rcp_f32 v130, v130
    v_rcp_f32 v131, v131
    v_mfma_f32_32x32x16_bf16 v[152:167], v[64:67], v[200:203], v[152:167]
    v_rcp_f32 v132, v132
    v_rcp_f32 v133, v133
    v_rcp_f32 v134, v134
    v_mfma_f32_32x32x16_bf16 v[168:183], v[64:67], v[204:207], v[168:183]
    v_rcp_f32 v135, v135
    v_rcp_f32 v136, v136
    v_rcp_f32 v137, v137
    v_mfma_f32_32x32x16_bf16 v[152:167], v[68:71], v[208:211], v[152:167]
    v_rcp_f32 v138, v138
    v_rcp_f32 v139, v139
    v_rcp_f32 v140, v140
    v_mfma_f32_32x32x16_bf16 v[168:183], v[68:71], v[212:215], v[168:183]
    v_rcp_f32 v141, v141
    v_rcp_f32 v142, v142
    v_rcp_f32 v143, v143
    v_mfma_f32_32x32x16_bf16 v[152:167], v[52:55], v[216:219], v[152:167]
    v_rcp_f32 v144, v144
    v_rcp_f32 v145, v145
    v_rcp_f32 v146, v146
    v_mfma_f32_32x32x16_bf16 v[168:183], v[52:55], v[220:223], v[168:183]
    v_rcp_f32 v147, v147
    v_rcp_f32 v148, v148
    v_rcp_f32 v149, v149
    v_lshl_add_u64 v[32:33], v[28:29], 0, v[14:15]
    v_rcp_f32 v150, v150
    v_lshl_add_u64 v[24:25], v[72:73], 0, v[26:27]
    v_rcp_f32 v151, v151
    s_setprio 0
    s_add_u32 m0, s41, 4096
    ds_read2_b32 v[4:5], v32 offset0:0 offset1:0
    buffer_load_dwordx4 v[50:51], s[28:31], 0 idxen offen lds
    s_add_u32 m0, s41, 0
    ds_read2_b32 v[6:7], v32 offset0:1 offset1:1
    buffer_load_dwordx4 v[42:43], s[24:27], 0 idxen offen offset:0 lds
    ds_read2_b32 v[8:9], v33 offset0:0 offset1:0
    buffer_load_dwordx4 v[44:45], s[24:27], 0 idxen offen offset:1024 lds
    ds_read2_b32 v[10:11], v33 offset0:1 offset1:1
    buffer_load_dwordx4 v[46:47], s[24:27], 0 idxen offen offset:2048 lds
    ds_read_b32 v50, v25
    buffer_load_dwordx4 v[48:49], s[24:27], 0 idxen offen offset:3072 lds
    ds_read_b32 v42, v24 offset:0
    ds_read_b32 v44, v24 offset:16
    ds_read_b32 v46, v24 offset:32
    ds_read_b32 v48, v24 offset:48
.p2align 3
    v_pk_mul_f32 v[16:17], v[120:121], v[88:89]
    v_pk_mul_f32 v[18:19], v[128:129], v[96:97]
    v_pk_mul_f32 v[20:21], v[136:137], v[104:105]
    v_pk_mul_f32 v[22:23], v[144:145], v[112:113]
    v_pk_fma_f32 v[16:17], v[122:123], v[90:91], v[16:17]
    v_pk_fma_f32 v[18:19], v[130:131], v[98:99], v[18:19]
    v_pk_fma_f32 v[20:21], v[138:139], v[106:107], v[20:21]
    v_pk_fma_f32 v[22:23], v[146:147], v[114:115], v[22:23]
    v_pk_fma_f32 v[16:17], v[124:125], v[92:93], v[16:17]
    v_pk_fma_f32 v[18:19], v[132:133], v[100:101], v[18:19]
    v_pk_fma_f32 v[20:21], v[140:141], v[108:109], v[20:21]
    v_pk_fma_f32 v[22:23], v[148:149], v[116:117], v[22:23]
    v_pk_fma_f32 v[16:17], v[126:127], v[94:95], v[16:17]
    v_pk_fma_f32 v[18:19], v[134:135], v[102:103], v[18:19]
    v_pk_fma_f32 v[20:21], v[142:143], v[110:111], v[20:21]
    v_pk_fma_f32 v[22:23], v[150:151], v[118:119], v[22:23]
    v_add_f32 v16, v16, v17
    v_add_f32 v18, v18, v19
    v_add_f32 v20, v20, v21
    v_add_f32 v22, v22, v23
    v_cvt_f64_f32 v[16:17], v16
    v_cvt_f64_f32 v[18:19], v18
    v_cvt_f64_f32 v[20:21], v20
    v_cvt_f64_f32 v[22:23], v22
    v_mfma_f32_32x32x16_bf16 v[88:103], v[56:59], v[224:227], 0
    s_setprio 1
    v_exp_f32 v152, v152
    v_exp_f32 v153, v153
    v_exp_f32 v154, v154
    v_mfma_f32_32x32x16_bf16 v[104:119], v[56:59], v[228:231], 0
    v_exp_f32 v155, v155
    v_exp_f32 v156, v156
    v_exp_f32 v157, v157
    v_mfma_f32_32x32x16_bf16 v[88:103], v[60:63], v[232:235], v[88:103]
    v_exp_f32 v158, v158
    v_exp_f32 v159, v159
    v_exp_f32 v160, v160
    v_mfma_f32_32x32x16_bf16 v[104:119], v[60:63], v[236:239], v[104:119]
    v_exp_f32 v161, v161
    v_exp_f32 v162, v162
    v_exp_f32 v163, v163
    v_mfma_f32_32x32x16_bf16 v[88:103], v[64:67], v[240:243], v[88:103]
    v_exp_f32 v164, v164
    v_exp_f32 v165, v165
    v_exp_f32 v166, v166
    v_mfma_f32_32x32x16_bf16 v[104:119], v[64:67], v[244:247], v[104:119]
    v_exp_f32 v167, v167
    v_exp_f32 v168, v168
    v_exp_f32 v169, v169
    v_mfma_f32_32x32x16_bf16 v[88:103], v[68:71], v[248:251], v[88:103]
    v_exp_f32 v170, v170
    v_exp_f32 v171, v171
    v_exp_f32 v172, v172
    v_mfma_f32_32x32x16_bf16 v[104:119], v[68:71], v[252:255], v[104:119]
    v_exp_f32 v173, v173
    v_exp_f32 v174, v174
    v_exp_f32 v175, v175
    v_exp_f32 v176, v176
    v_exp_f32 v177, v177
    v_exp_f32 v178, v178
    v_exp_f32 v179, v179
    v_exp_f32 v180, v180
    v_exp_f32 v181, v181
    v_exp_f32 v182, v182
    v_exp_f32 v183, v183
    s_sub_u32 s21, s21, 1
    s_cbranch_scc1 B_tail1
    s_setprio 0
    s_waitcnt vmcnt(0) lgkmcnt(0)
    ds_read_b128 v[56:59], v38 offset:0
    ds_read_b128 v[60:63], v39 offset:0
    ds_read_b128 v[64:67], v40 offset:0
    ds_read_b128 v[68:71], v41 offset:0
    ds_read_b128 v[52:55], v37 offset:0
    ds_add_f64 v30, v[16:17] offset:256
    ds_add_f64 v31, v[18:19] offset:256
    ds_add_f64 v30, v[20:21] offset:512
    ds_add_f64 v31, v[22:23] offset:512
    ds_read2_b32 v[28:29], v34 offset0:129 offset1:131
    ds_read2_b32 v[72:73], v35 offset0:64 offset1:64
.p2align 3
    v_pk_fma_f32 v[152:153], v[152:153], v[4:5], s[98:99]
    v_pk_fma_f32 v[154:155], v[154:155], v[4:5], s[98:99]
    v_pk_fma_f32 v[156:157], v[156:157], v[4:5], s[98:99]
    v_pk_fma_f32 v[158:159], v[158:159], v[4:5], s[98:99]
    v_pk_fma_f32 v[160:161], v[160:161], v[8:9], s[98:99]
    v_pk_fma_f32 v[162:163], v[162:163], v[8:9], s[98:99]
    v_pk_fma_f32 v[164:165], v[164:165], v[8:9], s[98:99]
    v_pk_fma_f32 v[166:167], v[166:167], v[8:9], s[98:99]
    v_pk_fma_f32 v[168:169], v[168:169], v[6:7], s[98:99]
    v_pk_fma_f32 v[170:171], v[170:171], v[6:7], s[98:99]
    v_pk_fma_f32 v[172:173], v[172:173], v[6:7], s[98:99]
    v_pk_fma_f32 v[174:175], v[174:175], v[6:7], s[98:99]
    v_pk_fma_f32 v[176:177], v[176:177], v[10:11], s[98:99]
    v_pk_fma_f32 v[178:179], v[178:179], v[10:11], s[98:99]
    v_pk_fma_f32 v[180:181], v[180:181], v[10:11], s[98:99]
    v_pk_fma_f32 v[182:183], v[182:183], v[10:11], s[98:99]
    s_waitcnt lgkmcnt(0)
    v_mfma_f32_32x32x16_bf16 v[120:135], v[56:59], v[184:187], 0
    s_setprio 1
    v_rcp_f32 v152, v152
    v_rcp_f32 v153, v153
    v_rcp_f32 v154, v154
    v_mfma_f32_32x32x16_bf16 v[136:151], v[56:59], v[188:191], 0
    v_rcp_f32 v155, v155
    v_rcp_f32 v156, v156
    v_rcp_f32 v157, v157
    v_mfma_f32_32x32x16_bf16 v[120:135], v[60:63], v[192:195], v[120:135]
    v_rcp_f32 v158, v158
    v_rcp_f32 v159, v159
    v_rcp_f32 v160, v160
    v_mfma_f32_32x32x16_bf16 v[136:151], v[60:63], v[196:199], v[136:151]
    v_rcp_f32 v161, v161
    v_rcp_f32 v162, v162
    v_rcp_f32 v163, v163
    v_mfma_f32_32x32x16_bf16 v[120:135], v[64:67], v[200:203], v[120:135]
    v_rcp_f32 v164, v164
    v_rcp_f32 v165, v165
    v_rcp_f32 v166, v166
    v_mfma_f32_32x32x16_bf16 v[136:151], v[64:67], v[204:207], v[136:151]
    v_rcp_f32 v167, v167
    v_rcp_f32 v168, v168
    v_rcp_f32 v169, v169
    v_mfma_f32_32x32x16_bf16 v[120:135], v[68:71], v[208:211], v[120:135]
    v_rcp_f32 v170, v170
    v_rcp_f32 v171, v171
    v_rcp_f32 v172, v172
    v_mfma_f32_32x32x16_bf16 v[136:151], v[68:71], v[212:215], v[136:151]
    v_rcp_f32 v173, v173
    v_rcp_f32 v174, v174
    v_rcp_f32 v175, v175
    v_mfma_f32_32x32x16_bf16 v[120:135], v[52:55], v[216:219], v[120:135]
    v_rcp_f32 v176, v176
    v_rcp_f32 v177, v177
    v_rcp_f32 v178, v178
    v_mfma_f32_32x32x16_bf16 v[136:151], v[52:55], v[220:223], v[136:151]
    v_rcp_f32 v179, v179
    v_rcp_f32 v180, v180
    v_rcp_f32 v181, v181
    v_lshl_add_u64 v[30:31], v[28:29], 0, v[14:15]
    v_rcp_f32 v182, v182
    v_lshl_add_u64 v[24:25], v[72:73], 0, v[26:27]
    v_rcp_f32 v183, v183
    s_setprio 0
    s_add_u32 m0, s41, 4096
    ds_read2_b32 v[4:5], v30 offset0:0 offset1:0
    buffer_load_dwordx4 v[50:51], s[28:31], 0 idxen offen lds
    s_add_u32 m0, s41, 0
    ds_read2_b32 v[6:7], v30 offset0:1 offset1:1
    buffer_load_dwordx4 v[42:43], s[24:27], 0 idxen offen offset:0 lds
    ds_read2_b32 v[8:9], v31 offset0:0 offset1:0
    buffer_load_dwordx4 v[44:45], s[24:27], 0 idxen offen offset:1024 lds
    ds_read2_b32 v[10:11], v31 offset0:1 offset1:1
    buffer_load_dwordx4 v[46:47], s[24:27], 0 idxen offen offset:2048 lds
    ds_read_b32 v50, v25
    buffer_load_dwordx4 v[48:49], s[24:27], 0 idxen offen offset:3072 lds
    ds_read_b32 v42, v24 offset:0
    ds_read_b32 v44, v24 offset:16
    ds_read_b32 v46, v24 offset:32
    ds_read_b32 v48, v24 offset:48
.p2align 3
    v_pk_mul_f32 v[16:17], v[152:153], v[88:89]
    v_pk_mul_f32 v[18:19], v[160:161], v[96:97]
    v_pk_mul_f32 v[20:21], v[168:169], v[104:105]
    v_pk_mul_f32 v[22:23], v[176:177], v[112:113]
    v_pk_fma_f32 v[16:17], v[154:155], v[90:91], v[16:17]
    v_pk_fma_f32 v[18:19], v[162:163], v[98:99], v[18:19]
    v_pk_fma_f32 v[20:21], v[170:171], v[106:107], v[20:21]
    v_pk_fma_f32 v[22:23], v[178:179], v[114:115], v[22:23]
    v_pk_fma_f32 v[16:17], v[156:157], v[92:93], v[16:17]
    v_pk_fma_f32 v[18:19], v[164:165], v[100:101], v[18:19]
    v_pk_fma_f32 v[20:21], v[172:173], v[108:109], v[20:21]
    v_pk_fma_f32 v[22:23], v[180:181], v[116:117], v[22:23]
    v_pk_fma_f32 v[16:17], v[158:159], v[94:95], v[16:17]
    v_pk_fma_f32 v[18:19], v[166:167], v[102:103], v[18:19]
    v_pk_fma_f32 v[20:21], v[174:175], v[110:111], v[20:21]
    v_pk_fma_f32 v[22:23], v[182:183], v[118:119], v[22:23]
    v_add_f32 v16, v16, v17
    v_add_f32 v18, v18, v19
    v_add_f32 v20, v20, v21
    v_add_f32 v22, v22, v23
    v_lshl_add_u64 v[34:35], v[34:35], 0, s[12:13]
    v_cvt_f64_f32 v[16:17], v16
    v_cvt_f64_f32 v[18:19], v18
    v_cvt_f64_f32 v[20:21], v20
    v_cvt_f64_f32 v[22:23], v22
    v_mfma_f32_32x32x16_bf16 v[88:103], v[56:59], v[224:227], 0
    s_setprio 1
    v_exp_f32 v120, v120
    v_exp_f32 v121, v121
    v_exp_f32 v122, v122
    v_mfma_f32_32x32x16_bf16 v[104:119], v[56:59], v[228:231], 0
    v_exp_f32 v123, v123
    v_exp_f32 v124, v124
    v_exp_f32 v125, v125
    v_mfma_f32_32x32x16_bf16 v[88:103], v[60:63], v[232:235], v[88:103]
    v_exp_f32 v126, v126
    v_exp_f32 v127, v127
    v_exp_f32 v128, v128
    v_mfma_f32_32x32x16_bf16 v[104:119], v[60:63], v[236:239], v[104:119]
    v_exp_f32 v129, v129
    v_exp_f32 v130, v130
    v_exp_f32 v131, v131
    v_mfma_f32_32x32x16_bf16 v[88:103], v[64:67], v[240:243], v[88:103]
    v_exp_f32 v132, v132
    v_exp_f32 v133, v133
    v_exp_f32 v134, v134
    v_mfma_f32_32x32x16_bf16 v[104:119], v[64:67], v[244:247], v[104:119]
    v_exp_f32 v135, v135
    v_exp_f32 v136, v136
    v_exp_f32 v137, v137
    v_mfma_f32_32x32x16_bf16 v[88:103], v[68:71], v[248:251], v[88:103]
    v_exp_f32 v138, v138
    v_exp_f32 v139, v139
    v_exp_f32 v140, v140
    v_mfma_f32_32x32x16_bf16 v[104:119], v[68:71], v[252:255], v[104:119]
    v_exp_f32 v141, v141
    v_exp_f32 v142, v142
    v_exp_f32 v143, v143
    v_exp_f32 v144, v144
    v_exp_f32 v145, v145
    v_exp_f32 v146, v146
    v_exp_f32 v147, v147
    v_exp_f32 v148, v148
    v_exp_f32 v149, v149
    v_exp_f32 v150, v150
    v_exp_f32 v151, v151
    s_branch F_loop
B_tail0:
    s_waitcnt lgkmcnt(0)
    ds_add_f64 v32, v[16:17] offset:256
    ds_add_f64 v33, v[18:19] offset:256
    ds_add_f64 v32, v[20:21] offset:512
    ds_add_f64 v33, v[22:23] offset:512
.p2align 3
    v_pk_fma_f32 v[120:121], v[120:121], v[4:5], s[98:99]
    v_pk_fma_f32 v[122:123], v[122:123], v[4:5], s[98:99]
    v_pk_fma_f32 v[124:125], v[124:125], v[4:5], s[98:99]
    v_pk_fma_f32 v[126:127], v[126:127], v[4:5], s[98:99]
    v_pk_fma_f32 v[128:129], v[128:129], v[8:9], s[98:99]
    v_pk_fma_f32 v[130:131], v[130:131], v[8:9], s[98:99]
    v_pk_fma_f32 v[132:133], v[132:133], v[8:9], s[98:99]
    v_pk_fma_f32 v[134:135], v[134:135], v[8:9], s[98:99]
    v_pk_fma_f32 v[136:137], v[136:137], v[6:7], s[98:99]
    v_pk_fma_f32 v[138:139], v[138:139], v[6:7], s[98:99]
    v_pk_fma_f32 v[140:141], v[140:141], v[6:7], s[98:99]
    v_pk_fma_f32 v[142:143], v[142:143], v[6:7], s[98:99]
    v_pk_fma_f32 v[144:145], v[144:145], v[10:11], s[98:99]
    v_pk_fma_f32 v[146:147], v[146:147], v[10:11], s[98:99]
    v_pk_fma_f32 v[148:149], v[148:149], v[10:11], s[98:99]
    v_pk_fma_f32 v[150:151], v[150:151], v[10:11], s[98:99]
    v_rcp_f32 v120, v120
    v_rcp_f32 v121, v121
    v_rcp_f32 v122, v122
    v_rcp_f32 v123, v123
    v_rcp_f32 v124, v124
    v_rcp_f32 v125, v125
    v_rcp_f32 v126, v126
    v_rcp_f32 v127, v127
    v_rcp_f32 v128, v128
    v_rcp_f32 v129, v129
    v_rcp_f32 v130, v130
    v_rcp_f32 v131, v131
    v_rcp_f32 v132, v132
    v_rcp_f32 v133, v133
    v_rcp_f32 v134, v134
    v_rcp_f32 v135, v135
    v_rcp_f32 v136, v136
    v_rcp_f32 v137, v137
    v_rcp_f32 v138, v138
    v_rcp_f32 v139, v139
    v_rcp_f32 v140, v140
    v_rcp_f32 v141, v141
    v_rcp_f32 v142, v142
    v_rcp_f32 v143, v143
    v_rcp_f32 v144, v144
    v_rcp_f32 v145, v145
    v_rcp_f32 v146, v146
    v_rcp_f32 v147, v147
    v_rcp_f32 v148, v148
    v_rcp_f32 v149, v149
    v_rcp_f32 v150, v150
    v_rcp_f32 v151, v151
.p2align 3
    v_pk_mul_f32 v[16:17], v[120:121], v[88:89]
    v_pk_mul_f32 v[18:19], v[128:129], v[96:97]
    v_pk_mul_f32 v[20:21], v[136:137], v[104:105]
    v_pk_mul_f32 v[22:23], v[144:145], v[112:113]
    v_pk_fma_f32 v[16:17], v[122:123], v[90:91], v[16:17]
    v_pk_fma_f32 v[18:19], v[130:131], v[98:99], v[18:19]
    v_pk_fma_f32 v[20:21], v[138:139], v[106:107], v[20:21]
    v_pk_fma_f32 v[22:23], v[146:147], v[114:115], v[22:23]
    v_pk_fma_f32 v[16:17], v[124:125], v[92:93], v[16:17]
    v_pk_fma_f32 v[18:19], v[132:133], v[100:101], v[18:19]
    v_pk_fma_f32 v[20:21], v[140:141], v[108:109], v[20:21]
    v_pk_fma_f32 v[22:23], v[148:149], v[116:117], v[22:23]
    v_pk_fma_f32 v[16:17], v[126:127], v[94:95], v[16:17]
    v_pk_fma_f32 v[18:19], v[134:135], v[102:103], v[18:19]
    v_pk_fma_f32 v[20:21], v[142:143], v[110:111], v[20:21]
    v_pk_fma_f32 v[22:23], v[150:151], v[118:119], v[22:23]
    v_add_f32 v16, v16, v17
    v_add_f32 v18, v18, v19
    v_add_f32 v20, v20, v21
    v_add_f32 v22, v22, v23
    v_cvt_f64_f32 v[16:17], v16
    v_cvt_f64_f32 v[18:19], v18
    v_cvt_f64_f32 v[20:21], v20
    v_cvt_f64_f32 v[22:23], v22
    s_branch B_exit0
B_tail1:
    s_waitcnt lgkmcnt(0)
    ds_add_f64 v30, v[16:17] offset:256
    ds_add_f64 v31, v[18:19] offset:256
    ds_add_f64 v30, v[20:21] offset:512
    ds_add_f64 v31, v[22:23] offset:512
.p2align 3
    v_pk_fma_f32 v[152:153], v[152:153], v[4:5], s[98:99]
    v_pk_fma_f32 v[154:155], v[154:155], v[4:5], s[98:99]
    v_pk_fma_f32 v[156:157], v[156:157], v[4:5], s[98:99]
    v_pk_fma_f32 v[158:159], v[158:159], v[4:5], s[98:99]
    v_pk_fma_f32 v[160:161], v[160:161], v[8:9], s[98:99]
    v_pk_fma_f32 v[162:163], v[162:163], v[8:9], s[98:99]
    v_pk_fma_f32 v[164:165], v[164:165], v[8:9], s[98:99]
    v_pk_fma_f32 v[166:167], v[166:167], v[8:9], s[98:99]
    v_pk_fma_f32 v[168:169], v[168:169], v[6:7], s[98:99]
    v_pk_fma_f32 v[170:171], v[170:171], v[6:7], s[98:99]
    v_pk_fma_f32 v[172:173], v[172:173], v[6:7], s[98:99]
    v_pk_fma_f32 v[174:175], v[174:175], v[6:7], s[98:99]
    v_pk_fma_f32 v[176:177], v[176:177], v[10:11], s[98:99]
    v_pk_fma_f32 v[178:179], v[178:179], v[10:11], s[98:99]
    v_pk_fma_f32 v[180:181], v[180:181], v[10:11], s[98:99]
    v_pk_fma_f32 v[182:183], v[182:183], v[10:11], s[98:99]
    v_rcp_f32 v152, v152
    v_rcp_f32 v153, v153
    v_rcp_f32 v154, v154
    v_rcp_f32 v155, v155
    v_rcp_f32 v156, v156
    v_rcp_f32 v157, v157
    v_rcp_f32 v158, v158
    v_rcp_f32 v159, v159
    v_rcp_f32 v160, v160
    v_rcp_f32 v161, v161
    v_rcp_f32 v162, v162
    v_rcp_f32 v163, v163
    v_rcp_f32 v164, v164
    v_rcp_f32 v165, v165
    v_rcp_f32 v166, v166
    v_rcp_f32 v167, v167
    v_rcp_f32 v168, v168
    v_rcp_f32 v169, v169
    v_rcp_f32 v170, v170
    v_rcp_f32 v171, v171
    v_rcp_f32 v172, v172
    v_rcp_f32 v173, v173
    v_rcp_f32 v174, v174
    v_rcp_f32 v175, v175
    v_rcp_f32 v176, v176
    v_rcp_f32 v177, v177
    v_rcp_f32 v178, v178
    v_rcp_f32 v179, v179
    v_rcp_f32 v180, v180
    v_rcp_f32 v181, v181
    v_rcp_f32 v182, v182
    v_rcp_f32 v183, v183
.p2align 3
    v_pk_mul_f32 v[16:17], v[152:153], v[88:89]
    v_pk_mul_f32 v[18:19], v[160:161], v[96:97]
    v_pk_mul_f32 v[20:21], v[168:169], v[104:105]
    v_pk_mul_f32 v[22:23], v[176:177], v[112:113]
    v_pk_fma_f32 v[16:17], v[154:155], v[90:91], v[16:17]
    v_pk_fma_f32 v[18:19], v[162:163], v[98:99], v[18:19]
    v_pk_fma_f32 v[20:21], v[170:171], v[106:107], v[20:21]
    v_pk_fma_f32 v[22:23], v[178:179], v[114:115], v[22:23]
    v_pk_fma_f32 v[16:17], v[156:157], v[92:93], v[16:17]
    v_pk_fma_f32 v[18:19], v[164:165], v[100:101], v[18:19]
    v_pk_fma_f32 v[20:21], v[172:173], v[108:109], v[20:21]
    v_pk_fma_f32 v[22:23], v[180:181], v[116:117], v[22:23]
    v_pk_fma_f32 v[16:17], v[158:159], v[94:95], v[16:17]
    v_pk_fma_f32 v[18:19], v[166:167], v[102:103], v[18:19]
    v_pk_fma_f32 v[20:21], v[174:175], v[110:111], v[20:21]
    v_pk_fma_f32 v[22:23], v[182:183], v[118:119], v[22:23]
    v_add_f32 v16, v16, v17
    v_add_f32 v18, v18, v19
    v_add_f32 v20, v20, v21
    v_add_f32 v22, v22, v23
    v_cvt_f64_f32 v[16:17], v16
    v_cvt_f64_f32 v[18:19], v18
    v_cvt_f64_f32 v[20:21], v20
    v_cvt_f64_f32 v[22:23], v22
B_exit1:
    v_mov_b64 v[30:31], v[32:33]
B_exit0:
    ds_add_f64 v30, v[16:17] offset:256
    ds_add_f64 v31, v[18:19] offset:256
    ds_add_f64 v30, v[20:21] offset:512
    ds_add_f64 v31, v[22:23] offset:512
B_loop_done:
    s_setprio 0
    v_lshrrev_b32 v1, 4, v0
    v_and_b32 v2, 15, v0
    v_lshlrev_b32 v12, 5, v2
    v_mul_u32_u24 v1, 768, v1
    v_add_u32 v12, v1, v12
    s_lshr_b32 s42, s81, 4
    s_sub_u32 s42, s42, s80
    s_lshl_b32 s42, s42, 4
    s_sub_u32 s42, s42, 128
    s_lshl_b32 s3, s80, 7
    v_lshlrev_b32 v13, 3, v0
    v_cmp_gt_u32 vcc, s42, v0
    s_cmp_lg_u32 s5, 0
    s_waitcnt lgkmcnt(0)
    s_barrier
    s_cbranch_scc1 B_round
    ds_read_b128 v[72:75], v12 offset:6400
    ds_read_b128 v[76:79], v12 offset:6416
    s_cmp_gt_u32 s40, 1
    s_cbranch_scc1 B_one
    ds_read_b128 v[80:83], v12 offset:256
    ds_read_b128 v[84:87], v12 offset:272
    s_setprio 1
    s_waitcnt lgkmcnt(0)
    v_cvt_f32_f64 v16, v[72:73]
    v_cvt_f32_f64 v17, v[74:75]
    v_cvt_f32_f64 v18, v[76:77]
    v_cvt_f32_f64 v19, v[78:79]
    v_cvt_f32_f64 v20, v[80:81]
    v_cvt_f32_f64 v21, v[82:83]
    v_cvt_f32_f64 v22, v[84:85]
    v_cvt_f32_f64 v23, v[86:87]
    v_mul_f32 v56, s96, v16
    v_mul_f32 v57, s96, v17
    v_mul_f32 v58, s96, v18
    v_mul_f32 v59, s96, v19
    v_mul_f32 v60, s96, v20
    v_mul_f32 v61, s96, v21
    v_mul_f32 v62, s96, v22
    v_mul_f32 v63, s96, v23
    v_exp_f32 v56, v56
    v_exp_f32 v57, v57
    v_exp_f32 v58, v58
    v_exp_f32 v59, v59
    v_exp_f32 v60, v60
    v_exp_f32 v61, v61
    v_exp_f32 v62, v62
    v_exp_f32 v63, v63
    v_add_f32 v56, 1.0, v56
    v_add_f32 v57, 1.0, v57
    v_add_f32 v58, 1.0, v58
    v_add_f32 v59, 1.0, v59
    v_add_f32 v60, 1.0, v60
    v_add_f32 v61, 1.0, v61
    v_add_f32 v62, 1.0, v62
    v_add_f32 v63, 1.0, v63
    v_rcp_f32 v56, v56
    v_rcp_f32 v57, v57
    v_rcp_f32 v58, v58
    v_rcp_f32 v59, v59
    v_rcp_f32 v60, v60
    v_rcp_f32 v61, v61
    v_rcp_f32 v62, v62
    v_rcp_f32 v63, v63
    v_mul_f32 v56, v16, v56
    v_mul_f32 v57, v17, v57
    v_mul_f32 v58, v18, v58
    v_mul_f32 v59, v19, v59
    v_mul_f32 v60, v20, v60
    v_mul_f32 v61, v21, v61
    v_mul_f32 v62, v22, v62
    v_mul_f32 v63, v23, v63
    v_cvt_pk_bf16_f32 v64, v56, v57
    v_cvt_pk_bf16_f32 v65, v58, v59
    v_cvt_pk_bf16_f32 v66, v60, v61
    v_cvt_pk_bf16_f32 v67, v62, v63
    buffer_store_dwordx2 v[64:65], v13, s[32:35], s3 offen offset:1024 sc1
    buffer_store_dwordx2 v[66:67], v13, s[32:35], s3 offen sc1
    s_branch B_fin
B_one:
    s_waitcnt lgkmcnt(0)
    v_cvt_f32_f64 v16, v[72:73]
    v_cvt_f32_f64 v17, v[74:75]
    v_cvt_f32_f64 v18, v[76:77]
    v_cvt_f32_f64 v19, v[78:79]
    v_mul_f32 v56, s96, v16
    v_mul_f32 v57, s96, v17
    v_mul_f32 v58, s96, v18
    v_mul_f32 v59, s96, v19
    v_exp_f32 v56, v56
    v_exp_f32 v57, v57
    v_exp_f32 v58, v58
    v_exp_f32 v59, v59
    v_add_f32 v56, 1.0, v56
    v_add_f32 v57, 1.0, v57
    v_add_f32 v58, 1.0, v58
    v_add_f32 v59, 1.0, v59
    v_rcp_f32 v56, v56
    v_rcp_f32 v57, v57
    v_rcp_f32 v58, v58
    v_rcp_f32 v59, v59
    v_mul_f32 v56, v16, v56
    v_mul_f32 v57, v17, v57
    v_mul_f32 v58, v18, v58
    v_mul_f32 v59, v19, v59
    v_cvt_pk_bf16_f32 v64, v56, v57
    v_cvt_pk_bf16_f32 v65, v58, v59
    s_mov_b64 exec, vcc
    buffer_store_dwordx2 v[64:65], v13, s[32:35], s3 offen offset:1024 sc1
B_gen:
B_fin:
B_end:
    s_endpgm
B_p1x:
    s_waitcnt lgkmcnt(0)
    s_lshr_b32 s3, s11, 24
    v_and_b32_sdwa v152, s78, v136 dst_sel:DWORD dst_unused:UNUSED_PAD src0_sel:DWORD src1_sel:BYTE_3
    v_and_b32_sdwa v153, s78, v137 dst_sel:DWORD dst_unused:UNUSED_PAD src0_sel:DWORD src1_sel:BYTE_3
    v_and_b32_sdwa v154, s78, v138 dst_sel:DWORD dst_unused:UNUSED_PAD src0_sel:DWORD src1_sel:BYTE_3
    v_subrev_u32 v152, s3, v152
    v_subrev_u32 v153, s3, v153
    v_subrev_u32 v154, s3, v154
    v_and_b32 v152, s78, v152
    v_and_b32 v153, s78, v153
    v_and_b32 v154, s78, v154
    v_and_b32 v113, 0xfff, v136
    v_add_u32 v113, v113, v9
    v_bfe_u32 v112, v136, 12, 14
    v_and_b32 v115, 0xfff, v137
    v_add_u32 v115, v115, v9
    v_bfe_u32 v114, v137, 12, 14
    v_and_b32 v117, 0xfff, v138
    v_add_u32 v117, v117, v9
    v_bfe_u32 v116, v138, 12, 14
    s_mov_b64 exec, s[72:73]
    ds_add_rtn_u32 v168, v152, v11 offset:30720
    s_mov_b64 exec, s[74:75]
    ds_add_rtn_u32 v169, v153, v11 offset:30720
    s_mov_b64 exec, s[76:77]
    ds_add_rtn_u32 v170, v154, v11 offset:30720
    s_mov_b64 exec, -1
    s_waitcnt lgkmcnt(0)
    v_lshl_add_u32 v68, v152, 8, v168
    v_lshl_add_u32 v69, v153, 8, v169
    v_lshl_add_u32 v70, v154, 8, v170
    v_add_u32 v68, v10, v68
    v_add_u32 v69, v10, v69
    v_add_u32 v70, v10, v70
    v_mov_b32 v10, 119300
    s_mov_b64 exec, s[72:73]
    ds_write_b64 v68, v[112:113]
    s_mov_b64 exec, s[74:75]
    ds_write_b64 v69, v[114:115]
    s_mov_b64 exec, s[76:77]
    ds_write_b64 v70, v[116:117]
    s_mov_b64 exec, s[46:47]
    ds_write_b32 v10, v11
    s_mov_b64 exec, -1
    s_branch B_p1done
B_p2x:
    s_mov_b64 exec, s[42:43]
B_grp_loop:
    s_waitcnt lgkmcnt(0)
    v_add_u32 v172, 768, v172
    ds_write_b64 v18, v[172:173]
    v_add_u32 v18, 96, v18
    v_cmpx_lt_u32 vcc, v18, v17
    s_cbranch_execnz B_grp_loop
    s_mov_b64 exec, -1
    s_cmp_eq_u32 s9, 0
    s_cbranch_scc1 B_p2done
B_warm_end:
    s_cmp_lg_u32 s101, 0
    s_cbranch_scc1 B_p2done
    s_cmp_gt_u32 s40, 3
    s_cbranch_scc1 B_p2done
    s_cmp_eq_u32 s8, 0
    s_cselect_b32 exec_hi, -1, 0
    s_cselect_b64 s[42:43], -1, 0
    s_waitcnt lgkmcnt(0)
    ds_write_b32 v54, v72 offset:0
    ds_write_b32 v54, v73 offset:768
    ds_write_b32 v54, v74 offset:1536
    ds_write_b32 v54, v75 offset:2304
    ds_write_b32 v54, v76 offset:3072
    ds_write_b32 v54, v77 offset:3840
    ds_write_b32 v54, v78 offset:4608
    ds_write_b32 v54, v79 offset:5376
    s_mov_b64 exec, s[42:43]
    s_waitcnt lgkmcnt(0)
    ds_write_b32 v54, v80 offset:6144
    ds_write_b32 v54, v81 offset:6912
    ds_write_b32 v54, v82 offset:7680
    ds_write_b32 v54, v83 offset:8448
    ds_write_b32 v54, v84 offset:9216
    ds_write_b32 v54, v85 offset:9984
    ds_write_b32 v54, v86 offset:10752
    ds_write_b32 v54, v87 offset:11520
    s_mov_b64 exec, -1
    s_branch B_p2done
B_giveup:
    s_mov_b64 exec, -1
    s_mov_b32 s10, 0
    v_mov_b32 v4, 0
    v_min_i32 v5, s20, v4
    v_sub_u32 v5, v5, v6
    v_cmp_lt_i32 s[46:47], s20, v4
    v_cmp_lt_i32 s[48:49], 0, v5
    v_cmp_lt_i32 s[50:51], 1, v5
    v_cmp_lt_i32 s[52:53], 2, v5
    v_cmp_lt_i32 s[54:55], 6, v5
    v_cmp_lt_i32 s[56:57], 7, v5
    v_cmp_lt_i32 s[58:59], 8, v5
    v_cmp_lt_i32 s[60:61], 12, v5
    v_cmp_lt_i32 s[62:63], 13, v5
    v_cmp_lt_i32 s[64:65], 14, v5
    v_cmp_lt_i32 s[66:67], 18, v5
    v_cmp_lt_i32 s[68:69], 19, v5
    v_cmp_lt_i32 s[70:71], 20, v5
    v_cmp_lt_i32 s[72:73], 24, v5
    v_cmp_lt_i32 s[74:75], 25, v5
    v_cmp_lt_i32 s[76:77], 26, v5
    s_branch B_sort
B_compact:
    s_cmp_gt_u32 s4, 4960
    s_cselect_b32 s3, 1, 0
    s_waitcnt lgkmcnt(0)
    v_mov_b32 v174, v16
    v_mov_b32 v175, v17
    v_mov_b32 v176, v10
    s_barrier
    v_mov_b32 v16, 2147483647
    v_mov_b32 v17, 2147483647
    v_mov_b32 v18, 2147483647
    v_mov_b32 v19, 2147483647
    v_mov_b32 v10, 119360
    v_lshl_add_u32 v10, v0, 4, v10
    ds_write_b128 v10, v[16:19] offset:0
    ds_write_b128 v10, v[16:19] offset:8192
    ds_write_b128 v10, v[16:19] offset:16384
    ds_write_b128 v10, v[16:19] offset:24576
    ds_write_b128 v10, v[16:19] offset:32768
    s_mov_b64 exec, 15
    ds_write_b128 v10, v[16:19] offset:40960
    s_mov_b64 exec, -1
    s_cmp_eq_u32 s3, 0
    s_cbranch_scc1 B_compact2
    v_mov_b32 v11, 0
    ds_write_b32 v176, v11 offset:30720
    s_mov_b32 s20, 18
    v_min_i32 v5, s20, v4
    v_sub_u32 v5, v5, v6
    v_cmp_lt_i32 s[46:47], s20, v4
    v_cmp_lt_i32 s[48:49], 0, v5
    v_cmp_lt_i32 s[50:51], 1, v5
    v_cmp_lt_i32 s[52:53], 2, v5
    v_cmp_lt_i32 s[54:55], 6, v5
    v_cmp_lt_i32 s[56:57], 7, v5
    v_cmp_lt_i32 s[58:59], 8, v5
    v_cmp_lt_i32 s[60:61], 12, v5
    v_cmp_lt_i32 s[62:63], 13, v5
    v_cmp_lt_i32 s[64:65], 14, v5
    v_cmp_lt_i32 s[66:67], 18, v5
    v_cmp_lt_i32 s[68:69], 19, v5
    v_cmp_lt_i32 s[70:71], 20, v5
    v_cmp_lt_i32 s[72:73], 24, v5
    v_cmp_lt_i32 s[74:75], 25, v5
    v_cmp_lt_i32 s[76:77], 26, v5
    s_waitcnt lgkmcnt(0)
    s_barrier
    s_branch B_count
B_compact2:
    s_waitcnt lgkmcnt(0)
    s_barrier
    v_mov_b32 v10, 119424
    s_mov_b64 exec, s[48:49]
    ds_read_b32 v56, v140 offset:55552
    s_waitcnt lgkmcnt(0)
    v_lshl_add_u32 v56, v56, 3, v156
    v_add_u32 v56, v10, v56
    ds_write_b64 v56, v[88:89]
    s_mov_b64 exec, s[50:51]
    ds_read_b32 v57, v141 offset:55552
    s_waitcnt lgkmcnt(0)
    v_lshl_add_u32 v57, v57, 3, v157
    v_add_u32 v57, v10, v57
    ds_write_b64 v57, v[90:91]
    s_mov_b64 exec, s[52:53]
    ds_read_b32 v58, v142 offset:55552
    s_waitcnt lgkmcnt(0)
    v_lshl_add_u32 v58, v58, 3, v158
    v_add_u32 v58, v10, v58
    ds_write_b64 v58, v[92:93]
    s_mov_b64 exec, s[54:55]
    ds_read_b32 v59, v143 offset:55552
    s_waitcnt lgkmcnt(0)
    v_lshl_add_u32 v59, v59, 3, v159
    v_add_u32 v59, v10, v59
    ds_write_b64 v59, v[94:95]
    s_mov_b64 exec, s[56:57]
    ds_read_b32 v60, v144 offset:55552
    s_waitcnt lgkmcnt(0)
    v_lshl_add_u32 v60, v60, 3, v160
    v_add_u32 v60, v10, v60
    ds_write_b64 v60, v[96:97]
    s_mov_b64 exec, s[58:59]
    ds_read_b32 v61, v145 offset:55552
    s_waitcnt lgkmcnt(0)
    v_lshl_add_u32 v61, v61, 3, v161
    v_add_u32 v61, v10, v61
    ds_write_b64 v61, v[98:99]
    s_mov_b64 exec, s[60:61]
    ds_read_b32 v62, v146 offset:55552
    s_waitcnt lgkmcnt(0)
    v_lshl_add_u32 v62, v62, 3, v162
    v_add_u32 v62, v10, v62
    ds_write_b64 v62, v[100:101]
    s_mov_b64 exec, s[62:63]
    ds_read_b32 v63, v147 offset:55552
    s_waitcnt lgkmcnt(0)
    v_lshl_add_u32 v63, v63, 3, v163
    v_add_u32 v63, v10, v63
    ds_write_b64 v63, v[102:103]
    s_mov_b64 exec, s[64:65]
    ds_read_b32 v64, v148 offset:55552
    s_waitcnt lgkmcnt(0)
    v_lshl_add_u32 v64, v64, 3, v164
    v_add_u32 v64, v10, v64
    ds_write_b64 v64, v[104:105]
    s_mov_b64 exec, s[66:67]
    ds_read_b32 v65, v149 offset:55552
    s_waitcnt lgkmcnt(0)
    v_lshl_add_u32 v65, v65, 3, v165
    v_add_u32 v65, v10, v65
    ds_write_b64 v65, v[106:107]
    s_mov_b64 exec, s[68:69]
    ds_read_b32 v66, v150 offset:55552
    s_waitcnt lgkmcnt(0)
    v_lshl_add_u32 v66, v66, 3, v166
    v_add_u32 v66, v10, v66
    ds_write_b64 v66, v[108:109]
    s_mov_b64 exec, s[70:71]
    ds_read_b32 v67, v151 offset:55552
    s_waitcnt lgkmcnt(0)
    v_lshl_add_u32 v67, v67, 3, v167
    v_add_u32 v67, v10, v67
    ds_write_b64 v67, v[110:111]
    s_mov_b64 exec, s[72:73]
    ds_read_b32 v68, v152 offset:55552
    s_waitcnt lgkmcnt(0)
    v_lshl_add_u32 v68, v68, 3, v168
    v_add_u32 v68, v10, v68
    ds_write_b64 v68, v[112:113]
    s_mov_b64 exec, s[74:75]
    ds_read_b32 v69, v153 offset:55552
    s_waitcnt lgkmcnt(0)
    v_lshl_add_u32 v69, v69, 3, v169
    v_add_u32 v69, v10, v69
    ds_write_b64 v69, v[114:115]
    s_mov_b64 exec, s[76:77]
    ds_read_b32 v70, v154 offset:55552
    s_waitcnt lgkmcnt(0)
    v_lshl_add_u32 v70, v70, 3, v170
    v_add_u32 v70, v10, v70
    ds_write_b64 v70, v[116:117]
    s_mov_b64 exec, -1
    v_mov_b32 v16, v174
    v_mov_b32 v17, v175
    v_lshl_add_u32 v172, v16, 3, v21
    v_add_u32 v172, v172, v10
    s_branch B_groups
B_slow:
    s_nop 15
    s_waitcnt lgkmcnt(0)
    v_pk_add_f32 v[120:121], v[120:121], v[4:5]
    v_pk_add_f32 v[122:123], v[122:123], v[4:5]
    v_pk_add_f32 v[124:125], v[124:125], v[4:5]
    v_pk_add_f32 v[126:127], v[126:127], v[4:5]
    v_pk_add_f32 v[128:129], v[128:129], v[8:9]
    v_pk_add_f32 v[130:131], v[130:131], v[8:9]
    v_pk_add_f32 v[132:133], v[132:133], v[8:9]
    v_pk_add_f32 v[134:135], v[134:135], v[8:9]
    v_pk_add_f32 v[136:137], v[136:137], v[6:7]
    v_pk_add_f32 v[138:139], v[138:139], v[6:7]
    v_pk_add_f32 v[140:141], v[140:141], v[6:7]
    v_pk_add_f32 v[142:143], v[142:143], v[6:7]
    v_pk_add_f32 v[144:145], v[144:145], v[10:11]
    v_pk_add_f32 v[146:147], v[146:147], v[10:11]
    v_pk_add_f32 v[148:149], v[148:149], v[10:11]
    v_pk_add_f32 v[150:151], v[150:151], v[10:11]
    v_mfma_f32_32x32x16_bf16 v[88:103], v[56:59], v[224:227], 0
    s_setprio 1
    v_exp_f32 v120, v120
    v_exp_f32 v121, v121
    v_exp_f32 v122, v122
    v_mfma_f32_32x32x16_bf16 v[104:119], v[56:59], v[228:231], 0
    v_exp_f32 v123, v123
    v_exp_f32 v124, v124
    v_exp_f32 v125, v125
    v_mfma_f32_32x32x16_bf16 v[88:103], v[60:63], v[232:235], v[88:103]
    v_exp_f32 v126, v126
    v_exp_f32 v127, v127
    v_exp_f32 v128, v128
    v_mfma_f32_32x32x16_bf16 v[104:119], v[60:63], v[236:239], v[104:119]
    v_exp_f32 v129, v129
    v_exp_f32 v130, v130
    v_exp_f32 v131, v131
    v_mfma_f32_32x32x16_bf16 v[88:103], v[64:67], v[240:243], v[88:103]
    v_exp_f32 v132, v132
    v_exp_f32 v133, v133
    v_exp_f32 v134, v134
    v_mfma_f32_32x32x16_bf16 v[104:119], v[64:67], v[244:247], v[104:119]
    v_exp_f32 v135, v135
    v_exp_f32 v136, v136
    v_exp_f32 v137, v137
    v_mfma_f32_32x32x16_bf16 v[88:103], v[68:71], v[248:251], v[88:103]
    v_exp_f32 v138, v138
    v_exp_f32 v139, v139
    v_exp_f32 v140, v140
    v_mfma_f32_32x32x16_bf16 v[104:119], v[68:71], v[252:255], v[104:119]
    v_exp_f32 v141, v141
    v_exp_f32 v142, v142
    v_exp_f32 v143, v143
    v_exp_f32 v144, v144
    v_exp_f32 v145, v145
    v_exp_f32 v146, v146
    v_exp_f32 v147, v147
    v_exp_f32 v148, v148
    v_exp_f32 v149, v149
    v_exp_f32 v150, v150
    v_exp_f32 v151, v151
S_loop:
    s_setprio 0
    s_waitcnt vmcnt(0) lgkmcnt(0)
    ds_read_b128 v[56:59], v38 offset:0
    ds_read_b128 v[60:63], v39 offset:0
    ds_read_b128 v[64:67], v40 offset:0
    ds_read_b128 v[68:71], v41 offset:0
    ds_read_b128 v[52:55], v37 offset:0
    ds_add_f64 v32, v[16:17] offset:256
    ds_add_f64 v33, v[18:19] offset:256
    ds_add_f64 v32, v[20:21] offset:512
    ds_add_f64 v33, v[22:23] offset:512
    ds_read2_b32 v[28:29], v34 offset0:65 offset1:67
    ds_read2_b32 v[72:73], v35 offset0:0 offset1:0
.p2align 3
    v_pk_add_f32 v[120:121], v[120:121], s[98:99]
    v_pk_add_f32 v[122:123], v[122:123], s[98:99]
    v_pk_add_f32 v[124:125], v[124:125], s[98:99]
    v_pk_add_f32 v[126:127], v[126:127], s[98:99]
    v_pk_add_f32 v[128:129], v[128:129], s[98:99]
    v_pk_add_f32 v[130:131], v[130:131], s[98:99]
    v_pk_add_f32 v[132:133], v[132:133], s[98:99]
    v_pk_add_f32 v[134:135], v[134:135], s[98:99]
    v_pk_add_f32 v[136:137], v[136:137], s[98:99]
    v_pk_add_f32 v[138:139], v[138:139], s[98:99]
    v_pk_add_f32 v[140:141], v[140:141], s[98:99]
    v_pk_add_f32 v[142:143], v[142:143], s[98:99]
    v_pk_add_f32 v[144:145], v[144:145], s[98:99]
    v_pk_add_f32 v[146:147], v[146:147], s[98:99]
    v_pk_add_f32 v[148:149], v[148:149], s[98:99]
    v_pk_add_f32 v[150:151], v[150:151], s[98:99]
    s_waitcnt lgkmcnt(0)
    v_mfma_f32_32x32x16_bf16 v[152:167], v[56:59], v[184:187], 0
    s_setprio 1
    v_rcp_f32 v120, v120
    v_rcp_f32 v121, v121
    v_rcp_f32 v122, v122
    v_mfma_f32_32x32x16_bf16 v[168:183], v[56:59], v[188:191], 0
    v_rcp_f32 v123, v123
    v_rcp_f32 v124, v124
    v_rcp_f32 v125, v125
    v_mfma_f32_32x32x16_bf16 v[152:167], v[60:63], v[192:195], v[152:167]
    v_rcp_f32 v126, v126
    v_rcp_f32 v127, v127
    v_rcp_f32 v128, v128
    v_mfma_f32_32x32x16_bf16 v[168:183], v[60:63], v[196:199], v[168:183]
    v_rcp_f32 v129, v129
    v_rcp_f32 v130, v130
    v_rcp_f32 v131, v131
    v_mfma_f32_32x32x16_bf16 v[152:167], v[64:67], v[200:203], v[152:167]
    v_rcp_f32 v132, v132
    v_rcp_f32 v133, v133
    v_rcp_f32 v134, v134
    v_mfma_f32_32x32x16_bf16 v[168:183], v[64:67], v[204:207], v[168:183]
    v_rcp_f32 v135, v135
    v_rcp_f32 v136, v136
    v_rcp_f32 v137, v137
    v_mfma_f32_32x32x16_bf16 v[152:167], v[68:71], v[208:211], v[152:167]
    v_rcp_f32 v138, v138
    v_rcp_f32 v139, v139
    v_rcp_f32 v140, v140
    v_mfma_f32_32x32x16_bf16 v[168:183], v[68:71], v[212:215], v[168:183]
    v_rcp_f32 v141, v141
    v_rcp_f32 v142, v142
    v_rcp_f32 v143, v143
    v_mfma_f32_32x32x16_bf16 v[152:167], v[52:55], v[216:219], v[152:167]
    v_rcp_f32 v144, v144
    v_rcp_f32 v145, v145
    v_rcp_f32 v146, v146
    v_mfma_f32_32x32x16_bf16 v[168:183], v[52:55], v[220:223], v[168:183]
    v_rcp_f32 v147, v147
    v_rcp_f32 v148, v148
    v_rcp_f32 v149, v149
    v_lshl_add_u64 v[32:33], v[28:29], 0, v[14:15]
    v_rcp_f32 v150, v150
    v_lshl_add_u64 v[24:25], v[72:73], 0, v[26:27]
    v_rcp_f32 v151, v151
    s_setprio 0
    s_add_u32 m0, s41, 4096
    ds_read2_b32 v[4:5], v32 offset0:0 offset1:0
    buffer_load_dwordx4 v[50:51], s[28:31], 0 idxen offen lds
    s_add_u32 m0, s41, 0
    ds_read2_b32 v[6:7], v32 offset0:1 offset1:1
    buffer_load_dwordx4 v[42:43], s[24:27], 0 idxen offen offset:0 lds
    ds_read2_b32 v[8:9], v33 offset0:0 offset1:0
    buffer_load_dwordx4 v[44:45], s[24:27], 0 idxen offen offset:1024 lds
    ds_read2_b32 v[10:11], v33 offset0:1 offset1:1
    buffer_load_dwordx4 v[46:47], s[24:27], 0 idxen offen offset:2048 lds
    ds_read_b32 v50, v25
    buffer_load_dwordx4 v[48:49], s[24:27], 0 idxen offen offset:3072 lds
    ds_read_b32 v42, v24 offset:0
    ds_read_b32 v44, v24 offset:16
    ds_read_b32 v46, v24 offset:32
    ds_read_b32 v48, v24 offset:48
    s_sub_u32 s21, s21, 1
.p2align 3
    v_pk_mul_f32 v[16:17], v[120:121], v[88:89]
    v_pk_mul_f32 v[18:19], v[128:129], v[96:97]
    v_pk_mul_f32 v[20:21], v[136:137], v[104:105]
    v_pk_mul_f32 v[22:23], v[144:145], v[112:113]
    v_pk_fma_f32 v[16:17], v[122:123], v[90:91], v[16:17]
    v_pk_fma_f32 v[18:19], v[130:131], v[98:99], v[18:19]
    v_pk_fma_f32 v[20:21], v[138:139], v[106:107], v[20:21]
    v_pk_fma_f32 v[22:23], v[146:147], v[114:115], v[22:23]
    v_pk_fma_f32 v[16:17], v[124:125], v[92:93], v[16:17]
    v_pk_fma_f32 v[18:19], v[132:133], v[100:101], v[18:19]
    v_pk_fma_f32 v[20:21], v[140:141], v[108:109], v[20:21]
    v_pk_fma_f32 v[22:23], v[148:149], v[116:117], v[22:23]
    v_pk_fma_f32 v[16:17], v[126:127], v[94:95], v[16:17]
    v_pk_fma_f32 v[18:19], v[134:135], v[102:103], v[18:19]
    v_pk_fma_f32 v[20:21], v[142:143], v[110:111], v[20:21]
    v_pk_fma_f32 v[22:23], v[150:151], v[118:119], v[22:23]
    v_add_f32 v16, v16, v17
    v_add_f32 v18, v18, v19
    v_add_f32 v20, v20, v21
    v_add_f32 v22, v22, v23
    v_cvt_f64_f32 v[16:17], v16
    v_cvt_f64_f32 v[18:19], v18
    v_cvt_f64_f32 v[20:21], v20
    v_cvt_f64_f32 v[22:23], v22
    s_cbranch_scc1 B_exit0
    s_waitcnt lgkmcnt(0)
    v_pk_add_f32 v[152:153], v[152:153], v[4:5]
    v_pk_add_f32 v[154:155], v[154:155], v[4:5]
    v_pk_add_f32 v[156:157], v[156:157], v[4:5]
    v_pk_add_f32 v[158:159], v[158:159], v[4:5]
    v_pk_add_f32 v[160:161], v[160:161], v[8:9]
    v_pk_add_f32 v[162:163], v[162:163], v[8:9]
    v_pk_add_f32 v[164:165], v[164:165], v[8:9]
    v_pk_add_f32 v[166:167], v[166:167], v[8:9]
    v_pk_add_f32 v[168:169], v[168:169], v[6:7]
    v_pk_add_f32 v[170:171], v[170:171], v[6:7]
    v_pk_add_f32 v[172:173], v[172:173], v[6:7]
    v_pk_add_f32 v[174:175], v[174:175], v[6:7]
    v_pk_add_f32 v[176:177], v[176:177], v[10:11]
    v_pk_add_f32 v[178:179], v[178:179], v[10:11]
    v_pk_add_f32 v[180:181], v[180:181], v[10:11]
    v_pk_add_f32 v[182:183], v[182:183], v[10:11]
    v_mfma_f32_32x32x16_bf16 v[88:103], v[56:59], v[224:227], 0
    s_setprio 1
    v_exp_f32 v152, v152
    v_exp_f32 v153, v153
    v_exp_f32 v154, v154
    v_mfma_f32_32x32x16_bf16 v[104:119], v[56:59], v[228:231], 0
    v_exp_f32 v155, v155
    v_exp_f32 v156, v156
    v_exp_f32 v157, v157
    v_mfma_f32_32x32x16_bf16 v[88:103], v[60:63], v[232:235], v[88:103]
    v_exp_f32 v158, v158
    v_exp_f32 v159, v159
    v_exp_f32 v160, v160
    v_mfma_f32_32x32x16_bf16 v[104:119], v[60:63], v[236:239], v[104:119]
    v_exp_f32 v161, v161
    v_exp_f32 v162, v162
    v_exp_f32 v163, v163
    v_mfma_f32_32x32x16_bf16 v[88:103], v[64:67], v[240:243], v[88:103]
    v_exp_f32 v164, v164
    v_exp_f32 v165, v165
    v_exp_f32 v166, v166
    v_mfma_f32_32x32x16_bf16 v[104:119], v[64:67], v[244:247], v[104:119]
    v_exp_f32 v167, v167
    v_exp_f32 v168, v168
    v_exp_f32 v169, v169
    v_mfma_f32_32x32x16_bf16 v[88:103], v[68:71], v[248:251], v[88:103]
    v_exp_f32 v170, v170
    v_exp_f32 v171, v171
    v_exp_f32 v172, v172
    v_mfma_f32_32x32x16_bf16 v[104:119], v[68:71], v[252:255], v[104:119]
    v_exp_f32 v173, v173
    v_exp_f32 v174, v174
    v_exp_f32 v175, v175
    v_exp_f32 v176, v176
    v_exp_f32 v177, v177
    v_exp_f32 v178, v178
    v_exp_f32 v179, v179
    v_exp_f32 v180, v180
    v_exp_f32 v181, v181
    v_exp_f32 v182, v182
    v_exp_f32 v183, v183
    s_setprio 0
    s_waitcnt vmcnt(0) lgkmcnt(0)
    ds_read_b128 v[56:59], v38 offset:0
    ds_read_b128 v[60:63], v39 offset:0
    ds_read_b128 v[64:67], v40 offset:0
    ds_read_b128 v[68:71], v41 offset:0
    ds_read_b128 v[52:55], v37 offset:0
    ds_add_f64 v30, v[16:17] offset:256
    ds_add_f64 v31, v[18:19] offset:256
    ds_add_f64 v30, v[20:21] offset:512
    ds_add_f64 v31, v[22:23] offset:512
    ds_read2_b32 v[28:29], v34 offset0:129 offset1:131
    ds_read2_b32 v[72:73], v35 offset0:64 offset1:64
.p2align 3
    v_pk_add_f32 v[152:153], v[152:153], s[98:99]
    v_pk_add_f32 v[154:155], v[154:155], s[98:99]
    v_pk_add_f32 v[156:157], v[156:157], s[98:99]
    v_pk_add_f32 v[158:159], v[158:159], s[98:99]
    v_pk_add_f32 v[160:161], v[160:161], s[98:99]
    v_pk_add_f32 v[162:163], v[162:163], s[98:99]
    v_pk_add_f32 v[164:165], v[164:165], s[98:99]
    v_pk_add_f32 v[166:167], v[166:167], s[98:99]
    v_pk_add_f32 v[168:169], v[168:169], s[98:99]
    v_pk_add_f32 v[170:171], v[170:171], s[98:99]
    v_pk_add_f32 v[172:173], v[172:173], s[98:99]
    v_pk_add_f32 v[174:175], v[174:175], s[98:99]
    v_pk_add_f32 v[176:177], v[176:177], s[98:99]
    v_pk_add_f32 v[178:179], v[178:179], s[98:99]
    v_pk_add_f32 v[180:181], v[180:181], s[98:99]
    v_pk_add_f32 v[182:183], v[182:183], s[98:99]
    s_waitcnt lgkmcnt(0)
    v_mfma_f32_32x32x16_bf16 v[120:135], v[56:59], v[184:187], 0
    s_setprio 1
    v_rcp_f32 v152, v152
    v_rcp_f32 v153, v153
    v_rcp_f32 v154, v154
    v_mfma_f32_32x32x16_bf16 v[136:151], v[56:59], v[188:191], 0
    v_rcp_f32 v155, v155
    v_rcp_f32 v156, v156
    v_rcp_f32 v157, v157
    v_mfma_f32_32x32x16_bf16 v[120:135], v[60:63], v[192:195], v[120:135]
    v_rcp_f32 v158, v158
    v_rcp_f32 v159, v159
    v_rcp_f32 v160, v160
    v_mfma_f32_32x32x16_bf16 v[136:151], v[60:63], v[196:199], v[136:151]
    v_rcp_f32 v161, v161
    v_rcp_f32 v162, v162
    v_rcp_f32 v163, v163
    v_mfma_f32_32x32x16_bf16 v[120:135], v[64:67], v[200:203], v[120:135]
    v_rcp_f32 v164, v164
    v_rcp_f32 v165, v165
    v_rcp_f32 v166, v166
    v_mfma_f32_32x32x16_bf16 v[136:151], v[64:67], v[204:207], v[136:151]
    v_rcp_f32 v167, v167
    v_rcp_f32 v168, v168
    v_rcp_f32 v169, v169
    v_mfma_f32_32x32x16_bf16 v[120:135], v[68:71], v[208:211], v[120:135]
    v_rcp_f32 v170, v170
    v_rcp_f32 v171, v171
    v_rcp_f32 v172, v172
    v_mfma_f32_32x32x16_bf16 v[136:151], v[68:71], v[212:215], v[136:151]
    v_rcp_f32 v173, v173
    v_rcp_f32 v174, v174
    v_rcp_f32 v175, v175
    v_mfma_f32_32x32x16_bf16 v[120:135], v[52:55], v[216:219], v[120:135]
    v_rcp_f32 v176, v176
    v_rcp_f32 v177, v177
    v_rcp_f32 v178, v178
    v_mfma_f32_32x32x16_bf16 v[136:151], v[52:55], v[220:223], v[136:151]
    v_rcp_f32 v179, v179
    v_rcp_f32 v180, v180
    v_rcp_f32 v181, v181
    v_lshl_add_u64 v[30:31], v[28:29], 0, v[14:15]
    v_rcp_f32 v182, v182
    v_lshl_add_u64 v[24:25], v[72:73], 0, v[26:27]
    v_rcp_f32 v183, v183
    s_setprio 0
    s_add_u32 m0, s41, 4096
    ds_read2_b32 v[4:5], v30 offset0:0 offset1:0
    buffer_load_dwordx4 v[50:51], s[28:31], 0 idxen offen lds
    s_add_u32 m0, s41, 0
    ds_read2_b32 v[6:7], v30 offset0:1 offset1:1
    buffer_load_dwordx4 v[42:43], s[24:27], 0 idxen offen offset:0 lds
    ds_read2_b32 v[8:9], v31 offset0:0 offset1:0
    buffer_load_dwordx4 v[44:45], s[24:27], 0 idxen offen offset:1024 lds
    ds_read2_b32 v[10:11], v31 offset0:1 offset1:1
    buffer_load_dwordx4 v[46:47], s[24:27], 0 idxen offen offset:2048 lds
    ds_read_b32 v50, v25
    buffer_load_dwordx4 v[48:49], s[24:27], 0 idxen offen offset:3072 lds
    ds_read_b32 v42, v24 offset:0
    ds_read_b32 v44, v24 offset:16
    ds_read_b32 v46, v24 offset:32
    ds_read_b32 v48, v24 offset:48
    s_sub_u32 s21, s21, 1
.p2align 3
    v_pk_mul_f32 v[16:17], v[152:153], v[88:89]
    v_pk_mul_f32 v[18:19], v[160:161], v[96:97]
    v_pk_mul_f32 v[20:21], v[168:169], v[104:105]
    v_pk_mul_f32 v[22:23], v[176:177], v[112:113]
    v_pk_fma_f32 v[16:17], v[154:155], v[90:91], v[16:17]
    v_pk_fma_f32 v[18:19], v[162:163], v[98:99], v[18:19]
    v_pk_fma_f32 v[20:21], v[170:171], v[106:107], v[20:21]
    v_pk_fma_f32 v[22:23], v[178:179], v[114:115], v[22:23]
    v_pk_fma_f32 v[16:17], v[156:157], v[92:93], v[16:17]
    v_pk_fma_f32 v[18:19], v[164:165], v[100:101], v[18:19]
    v_pk_fma_f32 v[20:21], v[172:173], v[108:109], v[20:21]
    v_pk_fma_f32 v[22:23], v[180:181], v[116:117], v[22:23]
    v_pk_fma_f32 v[16:17], v[158:159], v[94:95], v[16:17]
    v_pk_fma_f32 v[18:19], v[166:167], v[102:103], v[18:19]
    v_pk_fma_f32 v[20:21], v[174:175], v[110:111], v[20:21]
    v_pk_fma_f32 v[22:23], v[182:183], v[118:119], v[22:23]
    v_add_f32 v16, v16, v17
    v_add_f32 v18, v18, v19
    v_add_f32 v20, v20, v21
    v_add_f32 v22, v22, v23
    v_lshl_add_u64 v[34:35], v[34:35], 0, s[12:13]
    v_cvt_f64_f32 v[16:17], v16
    v_cvt_f64_f32 v[18:19], v18
    v_cvt_f64_f32 v[20:21], v20
    v_cvt_f64_f32 v[22:23], v22
    s_cbranch_scc1 B_exit1
    s_waitcnt lgkmcnt(0)
    v_pk_add_f32 v[120:121], v[120:121], v[4:5]
    v_pk_add_f32 v[122:123], v[122:123], v[4:5]
    v_pk_add_f32 v[124:125], v[124:125], v[4:5]
    v_pk_add_f32 v[126:127], v[126:127], v[4:5]
    v_pk_add_f32 v[128:129], v[128:129], v[8:9]
    v_pk_add_f32 v[130:131], v[130:131], v[8:9]
    v_pk_add_f32 v[132:133], v[132:133], v[8:9]
    v_pk_add_f32 v[134:135], v[134:135], v[8:9]
    v_pk_add_f32 v[136:137], v[136:137], v[6:7]
    v_pk_add_f32 v[138:139], v[138:139], v[6:7]
    v_pk_add_f32 v[140:141], v[140:141], v[6:7]
    v_pk_add_f32 v[142:143], v[142:143], v[6:7]
    v_pk_add_f32 v[144:145], v[144:145], v[10:11]
    v_pk_add_f32 v[146:147], v[146:147], v[10:11]
    v_pk_add_f32 v[148:149], v[148:149], v[10:11]
    v_pk_add_f32 v[150:151], v[150:151], v[10:11]
    v_mfma_f32_32x32x16_bf16 v[88:103], v[56:59], v[224:227], 0
    s_setprio 1
    v_exp_f32 v120, v120
    v_exp_f32 v121, v121
    v_exp_f32 v122, v122
    v_mfma_f32_32x32x16_bf16 v[104:119], v[56:59], v[228:231], 0
    v_exp_f32 v123, v123
    v_exp_f32 v124, v124
    v_exp_f32 v125, v125
    v_mfma_f32_32x32x16_bf16 v[88:103], v[60:63], v[232:235], v[88:103]
    v_exp_f32 v126, v126
    v_exp_f32 v127, v127
    v_exp_f32 v128, v128
    v_mfma_f32_32x32x16_bf16 v[104:119], v[60:63], v[236:239], v[104:119]
    v_exp_f32 v129, v129
    v_exp_f32 v130, v130
    v_exp_f32 v131, v131
    v_mfma_f32_32x32x16_bf16 v[88:103], v[64:67], v[240:243], v[88:103]
    v_exp_f32 v132, v132
    v_exp_f32 v133, v133
    v_exp_f32 v134, v134
    v_mfma_f32_32x32x16_bf16 v[104:119], v[64:67], v[244:247], v[104:119]
    v_exp_f32 v135, v135
    v_exp_f32 v136, v136
    v_exp_f32 v137, v137
    v_mfma_f32_32x32x16_bf16 v[88:103], v[68:71], v[248:251], v[88:103]
    v_exp_f32 v138, v138
    v_exp_f32 v139, v139
    v_exp_f32 v140, v140
    v_mfma_f32_32x32x16_bf16 v[104:119], v[68:71], v[252:255], v[104:119]
    v_exp_f32 v141, v141
    v_exp_f32 v142, v142
    v_exp_f32 v143, v143
    v_exp_f32 v144, v144
    v_exp_f32 v145, v145
    v_exp_f32 v146, v146
    v_exp_f32 v147, v147
    v_exp_f32 v148, v148
    v_exp_f32 v149, v149
    v_exp_f32 v150, v150
    v_exp_f32 v151, v151
    s_branch S_loop
B_round:
    s_add_u32 s101, s101, s20
    s_mov_b32 s20, 30
    v_and_b32 v7, 63, v0
    v_lshrrev_b32 v8, 1, v0
    s_lshl_b32 s3, s100, 3
    s_add_u32 s3, s3, 4161792
    v_mul_u32_u24 v3, 2176, v8
    v_add_u32 v3, s3, v3
    v_and_b32 v6, 1, v0
    v_mul_u32_u24 v9, 2500, v8
    v_mul_u32_u24 v2, 16256, v8
    v_lshl_add_u32 v2, v6, 4, v2
    v_mul_u32_u24 v6, 3, v6
    buffer_load_dwordx2 v[12:13], v3, s[36:39], 0 offen sc1
    v_mov_b32 v16, 2147483647
    v_mov_b32 v17, 2147483647
    v_mov_b32 v18, 2147483647
    v_mov_b32 v19, 2147483647
    v_mov_b32 v10, 119360
    v_lshl_add_u32 v10, v0, 4, v10
    ds_write_b128 v10, v[16:19] offset:0
    ds_write_b128 v10, v[16:19] offset:8192
    ds_write_b128 v10, v[16:19] offset:16384
    ds_write_b128 v10, v[16:19] offset:24576
    ds_write_b128 v10, v[16:19] offset:32768
    s_mov_b64 exec, 15
    ds_write_b128 v10, v[16:19] offset:40960
    s_mov_b64 exec, -1
    v_cmp_gt_u32 vcc, 400, v0
    v_mov_b32 v16, 119360
    v_mov_b32 v17, 0
    v_mov_b32 v11, 112896
    v_cndmask_b32 v16, 0, v16, vcc
    v_cmp_ge_u32 vcc, 400, v0
    v_lshl_add_u32 v11, v0, 4, v11
    v_mov_b64 v[18:19], v[16:17]
    s_mov_b64 exec, vcc
    ds_write_b128 v11, v[16:19]
    s_mov_b64 exec, -1
    v_mul_u32_u24 v10, 43, v7
    v_lshrrev_b32 v10, 9, v10
    v_mul_u32_u24 v11, 12, v10
    v_sub_u32 v11, v7, v11
    s_mul_i32 s3, s40, 5
    v_add_u32 v10, s3, v10
    v_cmp_gt_u32 vcc, 60, v7
    v_lshlrev_b32 v22, 3, v11
    v_add_u32 v22, 112896, v22
    v_cndmask_b32 v10, 50, v10, vcc
    v_lshlrev_b32 v20, 2, v10
    v_add_u32 v20, 55552, v20
    v_mul_u32_u24 v173, 768, v10
    v_lshlrev_b32 v21, 6, v11
    v_lshl_add_u32 v172, v10, 10, v21
    v_add_u32 v172, 119424, v172
    s_lshl_b32 s42, s40, 5
    s_cmp_lt_u32 s40, 4
    s_mov_b32 s3, 112768
    s_cselect_b32 s3, s3, 113024
    s_add_u32 s42, s42, s3
    v_lshrrev_b32 v10, 5, v7
    v_lshl_add_u32 v34, v10, 4, s42
    v_lshrrev_b32 v10, 4, v7
    v_lshl_add_u32 v35, v10, 3, s42
    v_lshlrev_b32 v10, 2, v7
    v_mov_b32 v11, 0
    ds_write_b32 v10, v11 offset:30720
    s_waitcnt vmcnt(0)
    v_lshrrev_b32 v4, 16, v12
    v_and_b32 v1, 0xffff, v12
    v_lshl_add_u32 v1, v1, 2, v2
    v_subrev_u32 v4, s101, v4
    s_mul_i32 s3, s101, 2731
    s_lshr_b32 s3, s3, 13
    s_lshl_b32 s3, s3, 4
    v_add_u32 v1, s3, v1
    v_mov_b32 v123, s97
    v_mov_b32 v127, s97
    v_mov_b32 v131, s97
    v_mov_b32 v135, s97
    v_mov_b32 v139, s97
    v_sub_u32 v5, v4, v6
    v_cmpx_lt_i32 vcc, 0, v5
    buffer_load_dwordx4 v[120:123], v1, s[36:39], 0 offen offset:256 sc1
    v_cmpx_lt_i32 vcc, 6, v5
    buffer_load_dwordx4 v[124:127], v1, s[36:39], 0 offen offset:288 sc1
    v_cmpx_lt_i32 vcc, 12, v5
    buffer_load_dwordx4 v[128:131], v1, s[36:39], 0 offen offset:320 sc1
    v_cmpx_lt_i32 vcc, 18, v5
    buffer_load_dwordx4 v[132:135], v1, s[36:39], 0 offen offset:352 sc1
    v_cmpx_lt_i32 vcc, 24, v5
    buffer_load_dwordx4 v[136:139], v1, s[36:39], 0 offen offset:384 sc1
    s_mov_b64 exec, -1
    v_min_i32 v5, s20, v4
    v_sub_u32 v5, v5, v6
    v_cmp_lt_i32 s[46:47], s20, v4
    v_cmp_lt_i32 s[48:49], 0, v5
    v_cmp_lt_i32 s[50:51], 1, v5
    v_cmp_lt_i32 s[52:53], 2, v5
    v_cmp_lt_i32 s[54:55], 6, v5
    v_cmp_lt_i32 s[56:57], 7, v5
    v_cmp_lt_i32 s[58:59], 8, v5
    v_cmp_lt_i32 s[60:61], 12, v5
    v_cmp_lt_i32 s[62:63], 13, v5
    v_cmp_lt_i32 s[64:65], 14, v5
    v_cmp_lt_i32 s[66:67], 18, v5
    v_cmp_lt_i32 s[68:69], 19, v5
    v_cmp_lt_i32 s[70:71], 20, v5
    v_cmp_lt_i32 s[72:73], 24, v5
    v_cmp_lt_i32 s[74:75], 25, v5
    v_cmp_lt_i32 s[76:77], 26, v5
    s_waitcnt vmcnt(0) lgkmcnt(0)
    s_barrier
    s_branch B_verify
.section .rodata,"a"
.p2align 6
.amdhsa_kernel standalone__edge_featured_mpnn_egc__graph_kernel
  .amdhsa_next_free_vgpr 256
  .amdhsa_next_free_sgpr 102
  .amdhsa_accum_offset 256
  .amdhsa_group_segment_fixed_size 0
  .amdhsa_kernarg_size 80
  .amdhsa_user_sgpr_count 2
  .amdhsa_user_sgpr_kernarg_segment_ptr 1
  .amdhsa_system_sgpr_workgroup_id_x 1
.end_amdhsa_kernel
```
